```python
import torch

def _softmax(x, axis=-1):
    return torch.softmax(x, dim=axis)
def _gelu(x):
    return torch.nn.functional.gelu(x, approximate="tanh")
def _silu(x):
    return torch.nn.functional.silu(x)
def _sigmoid(x):
    return torch.sigmoid(x)
def _layernorm(x, axis=-1, eps=1e-5):
    m = x.mean(dim=axis, keepdim=True)
    v = x.var(dim=axis, keepdim=True, unbiased=False)
    return (x - m) / torch.sqrt(v + eps)
def _scatter_add(tgt, idx, src, axis=0):
    return tgt.clone().index_add_(axis, idx, src)
def _segment_sum(src, seg, n):
    out = torch.zeros((n,) + src.shape[1:], dtype=src.dtype)
    return out.index_add_(0, seg, src)
def _pad(x, pw):
    flat = tuple(v for pair in reversed(pw) for v in pair)
    return torch.nn.functional.pad(x, flat)

kernel_name = 'recurrent_scan__mha_block_cached__glu_gated_reglu__decode'

def setup_inputs():

    _w = (lambda a: (lambda t: t.to(torch.bfloat16) if t.is_floating_point() else t)(torch.as_tensor(a)))
    def _A_setup():
        B, Sq, D = 1, 1, 640
        H, Sk, Dh = 32, 32768, 128
        return {
            "x": _w((lambda *s: torch.randn(*s, dtype=torch.bfloat16) * 0.4)(B, Sq, D)),
            "k_cache": _w((lambda *s: torch.randn(*s, dtype=torch.bfloat16) * 1.6)(B, H, Sk, Dh)),
            "v_cache": _w((lambda *s: torch.randn(*s, dtype=torch.bfloat16) * 1.6)(B, H, Sk, Dh)),
            "wq": _w((lambda *s: torch.randn(*s, dtype=torch.bfloat16) * 1.6)(D, H * Dh) * (D ** -0.5)),
            "wo": _w((lambda *s: torch.randn(*s, dtype=torch.bfloat16) * 1.6)(H * Dh, D) * ((H * Dh) ** -0.5)),
        }
    _A_in = _A_setup()

    def _B_setup():
        B, S, D, F = 1, 1, 640, 1728
        return {
            "x": _w((lambda *s: torch.randn(*s, dtype=torch.bfloat16) * 0.4)(B, S, D)),
            "W_gate": _w((lambda *s: torch.randn(*s, dtype=torch.bfloat16) * 1.6)(D, F) * (2.0 / D) ** 0.5),
            "W_up": _w((lambda *s: torch.randn(*s, dtype=torch.bfloat16) * 1.6)(D, F) * (2.0 / D) ** 0.5),
            "W_down": _w((lambda *s: torch.randn(*s, dtype=torch.bfloat16) * 1.6)(F, D) * (1.0 / F) ** 0.5),
        }
    _B_in = _B_setup()

    return {
        "A_x": _A_in["x"],
        "A_k_cache": _A_in["k_cache"],
        "A_v_cache": _A_in["v_cache"],
        "A_wq": _A_in["wq"],
        "A_wo": _A_in["wo"],
        "B_x": _B_in["x"],
        "B_W_gate": _B_in["W_gate"],
        "B_W_up": _B_in["W_up"],
        "B_W_down": _B_in["W_down"],
    }

def reference(A_x, A_k_cache, A_v_cache, A_wq, A_wo, B_x, B_W_gate, B_W_up, B_W_down):
    def _A_ref(x, k_cache, v_cache, wq, wo):
        B, Sq, D = x.shape
        H, Dh = 32, 128
        q = (lambda x, *d: x.permute(*d))((x @ wq).reshape(B, Sq, H, Dh), 0, 2, 1, 3)
        scores = torch.einsum("bhqd,bhkd->bhqk", q, k_cache) * (Dh ** -0.5)
        p = _softmax(scores, axis=-1)
        o = torch.einsum("bhqk,bhkd->bhqd", p, v_cache)
        return (lambda x, *d: x.permute(*d))(o, 0, 2, 1, 3).reshape(B, Sq, H * Dh) @ wo

    def _B_ref(x, W_gate, W_up, W_down):
        gate = torch.einsum("bsd,df->bsf", x, W_gate)
        up = torch.einsum("bsd,df->bsf", x, W_up)
        gate = gate * (lambda x, dt: x.to(dt))(gate > 0, gate.dtype)
        h = gate * up
        return torch.einsum("bsf,fd->bsd", h, W_down)

    x = A_x
    xn = _layernorm(x, axis=-1)
    s = _A_ref(xn, A_k_cache, A_v_cache, A_wq, A_wo)
    g = _silu(_B_ref(xn, B_W_gate, B_W_up, B_W_down))
    return x + s * g
```

```asm
; @launch grid=(256,1,1) block=(512,1,1) lds=21824
.amdgcn_target "amdgcn-amd-amdhsa--gfx950"
.text
.globl recurrent_scan__mha_block_cached__glu_gated_reglu__decode_kernel
.p2align 12
.p2align 8
.type recurrent_scan__mha_block_cached__glu_gated_reglu__decode_kernel,@function
recurrent_scan__mha_block_cached__glu_gated_reglu__decode_kernel:
  s_load_dwordx16 s[16:31], s[0:1], 0
  s_cmp_ge_u32 s2, 256
  s_cbranch_scc0 L_go
  s_endpgm
L_go:
  v_lshrrev_b32 v1, 6, v0
  v_and_b32 v0, 63, v0
  v_readfirstlane_b32 s3, v1
  s_and_b32 s4, s2, 7
  s_lshr_b32 s5, s2, 3
  s_lshl_b32 s4, s4, 2
  s_lshr_b32 s6, s5, 3
  s_add_u32 s4, s4, s6
  s_and_b32 s5, s5, 7
  s_lshl_b32 s6, s4, 3
  s_add_u32 s6, s6, s5
  v_lshrrev_b32 v1, 4, v0
  v_and_b32 v2, 15, v0
  s_cmp_ge_u32 s3, 4
  s_cbranch_scc1 L_helper
  v_lshlrev_b32 v4, 4, v0
  v_and_b32 v3, 48, v4
  v_lshl_add_u32 v3, v1, 6, v3
  v_bfe_u32 v5, v0, 2, 2
  v_lshl_add_u32 v3, v5, 8, v3
  s_lshl_b32 s14, s4, 23
  s_lshr_b32 s7, s5, 1
  s_lshl_b32 s7, s7, 10
  s_xor_b32 s14, s14, s7
  s_and_b32 s7, s5, 1
  s_mul_i32 s7, s7, 0x4400
  s_xor_b32 s14, s14, s7
  s_lshl_b32 s7, s3, 12
  s_xor_b32 s14, s14, s7
  s_lshr_b32 s13, s4, 1
  s_and_b32 s13, s13, 15
  s_lshl_b32 s46, s5, 2
  s_add_u32 s46, s46, s3
  v_add_u32 v48, 0x10000, v3
  v_add_u32 v49, 0x8000, v3
  v_add_u32 v50, 0x18000, v3
  s_mov_b32 s10, 268435456
  s_mov_b32 s11, 0x20000
  s_and_b32 s59, s13, 7
  s_mul_i32 s59, s59, 0x4800
  s_and_b32 s59, s59, 0x7000
  s_and_b32 s12, s13, 1
  s_lshl_b32 s12, s12, 10
  s_or_b32 s59, s59, s12
  s_lshl_b32 s12, s13, 19
  s_or_b32 s59, s59, s12
  s_xor_b32 s59, s59, s14
  s_add_u32 s13, s13, 1
  s_and_b32 s13, s13, 15
  s_waitcnt lgkmcnt(0)
  s_mov_b32 s8, s18
  s_mov_b32 s9, s19
  buffer_load_dwordx4 v[64:67], v3, s[8:11], s59 offen nt
  buffer_load_dwordx4 v[68:71], v48, s[8:11], s59 offen nt
  buffer_load_dwordx4 v[72:75], v49, s[8:11], s59 offen nt
  buffer_load_dwordx4 v[76:79], v50, s[8:11], s59 offen nt
  s_xor_b32 s12, s59, 0x20400
  buffer_load_dwordx4 v[80:83], v3, s[8:11], s12 offen nt
  v_and_b32 v6, 3, v2
  v_lshl_add_u32 v6, v1, 2, v6
  v_lshlrev_b32 v53, 4, v6
  v_and_b32 v6, 1, v1
  v_lshl_add_u32 v6, v2, 1, v6
  s_lshl_b32 s7, s3, 9
  v_lshl_add_u32 v60, v6, 4, s7
  v_and_b32 v6, 1, v0
  v_lshlrev_b32 v6, 4, v6
  v_mov_b32 v12, 0xffff
  v_lshlrev_b32 v6, v6, v12
  s_mov_b32 s40, 0x3030303
  s_mov_b32 s41, 0x3030303
  v_cndmask_b32 v12, 0, v6, s[40:41]
  s_mov_b32 s40, 0xc0c0c0c
  s_mov_b32 s41, 0xc0c0c0c
  v_cndmask_b32 v13, 0, v6, s[40:41]
  s_mov_b32 s40, 0x30303030
  s_mov_b32 s41, 0x30303030
  v_cndmask_b32 v14, 0, v6, s[40:41]
  s_mov_b32 s40, 0xc0c0c0c0
  s_mov_b32 s41, 0xc0c0c0c0
  v_cndmask_b32 v15, 0, v6, s[40:41]
  s_mov_b32 s40, 0xaaaaaaaa
  s_mov_b32 s41, 0xaaaaaaaa
  s_mov_b32 s42, 0xcccccccc
  s_mov_b32 s43, 0xcccccccc
  s_mov_b32 s57, 0x0
  s_mov_b32 s58, 0x0
  s_branch L_streamer
L_helper:
  s_load_dwordx8 s[32:39], s[0:1], 64
  s_sub_u32 s40, s3, 4
  s_cmp_eq_u32 s40, 3
  s_cbranch_scc0 L_h_notouch
  s_mul_i32 s42, s5, 655360
  s_mul_i32 s43, s5, 276480
  s_mul_i32 s44, s4, 81920
  s_min_u32 s44, s44, 2210560
  s_mul_i32 s45, s4, 163840
  s_lshl_b32 s46, s4, 23
  s_mov_b32 s47, 0x2f0000
  s_waitcnt lgkmcnt(0)
  s_load_dword s64, s[16:17], 0
  s_load_dword s65, s[22:23], s42
  s_load_dword s66, s[38:39], s47
  s_load_dword s67, s[28:29], s43
  s_load_dword s68, s[30:31], s43
  s_load_dword s69, s[32:33], s44
  s_load_dword s60, s[24:25], s45
  s_load_dword s61, s[34:35], 0
L_h_notouch:
  s_mul_i32 s7, s5, 160
  v_lshl_add_u32 v4, v2, 2, v1
  v_lshlrev_b32 v4, 1, v4
  v_lshlrev_b32 v3, 2, v0
  v_lshlrev_b32 v228, 4, v0
  s_cmp_eq_u32 s40, 0
  s_cbranch_scc0 L_h_noq
  v_lshlrev_b32 v8, 13, v1
  v_lshl_add_u32 v8, v2, 4, v8
  v_add_u32 v9, 0x8000, v8
  v_add_u32 v10, 0x10000, v8
  v_add_u32 v11, 0x18000, v8
  s_mul_i32 s42, s5, 655360
  s_lshl_b32 s43, s4, 8
  s_add_u32 s42, s42, s43
  s_waitcnt lgkmcnt(0)
  s_load_dword s54, s[38:39], 0xfc000
  s_mov_b32 s8, s16
  s_mov_b32 s9, s17
  s_mov_b32 s10, 1280
  s_mov_b32 s11, 0x20000
  s_mov_b32 s12, s22
  s_mov_b32 s13, s23
  s_mov_b32 s14, 5242880
  s_mov_b32 s15, 0x20000
  buffer_load_dword v16, v3, s[8:11], 0 offen offset:0
  buffer_load_dword v17, v3, s[8:11], 0 offen offset:256
  buffer_load_dword v18, v3, s[8:11], 0 offen offset:512
  buffer_load_dword v19, v3, s[8:11], 0 offen offset:768
  buffer_load_dword v20, v3, s[8:11], 0 offen offset:1024
  buffer_load_ushort v21, v4, s[8:11], s7 offen offset:0
  buffer_load_ushort v22, v4, s[8:11], s7 offen offset:128
  buffer_load_dwordx4 v[64:67], v8, s[12:15], s42 offen nt
  buffer_load_dwordx4 v[68:71], v9, s[12:15], s42 offen nt
  buffer_load_dwordx4 v[72:75], v10, s[12:15], s42 offen nt
  buffer_load_dwordx4 v[76:79], v11, s[12:15], s42 offen nt
  s_add_u32 s42, s42, 0x20000
  buffer_load_dwordx4 v[80:83], v8, s[12:15], s42 offen nt
  buffer_load_dwordx4 v[84:87], v9, s[12:15], s42 offen nt
  buffer_load_dwordx4 v[88:91], v10, s[12:15], s42 offen nt
  buffer_load_dwordx4 v[92:95], v11, s[12:15], s42 offen nt
  s_add_u32 s42, s42, 0x20000
  buffer_load_dwordx4 v[96:99], v8, s[12:15], s42 offen nt
  buffer_load_dwordx4 v[100:103], v9, s[12:15], s42 offen nt
  buffer_load_dwordx4 v[104:107], v10, s[12:15], s42 offen nt
  buffer_load_dwordx4 v[108:111], v11, s[12:15], s42 offen nt
  s_add_u32 s42, s42, 0x20000
  buffer_load_dwordx4 v[112:115], v8, s[12:15], s42 offen nt
  buffer_load_dwordx4 v[116:119], v9, s[12:15], s42 offen nt
  buffer_load_dwordx4 v[120:123], v10, s[12:15], s42 offen nt
  buffer_load_dwordx4 v[124:127], v11, s[12:15], s42 offen nt
  s_add_u32 s42, s42, 0x20000
  buffer_load_dwordx4 v[128:131], v8, s[12:15], s42 offen nt
  buffer_load_dwordx4 v[132:135], v9, s[12:15], s42 offen nt
  buffer_load_dwordx4 v[136:139], v10, s[12:15], s42 offen nt
  buffer_load_dwordx4 v[140:143], v11, s[12:15], s42 offen nt
  s_mov_b32 s48, s38
  s_mov_b32 s49, s39
  s_mov_b32 s50, 3145728
  s_mov_b32 s51, 0x20000
  v_and_b32 v6, 1, v0
  v_lshlrev_b32 v6, 4, v6
  v_mov_b32 v12, 0xffff
  v_lshlrev_b32 v6, v6, v12
  s_mov_b32 s44, 0x3030303
  s_mov_b32 s45, 0x3030303
  v_cndmask_b32 v12, 0, v6, s[44:45]
  s_mov_b32 s44, 0xc0c0c0c
  s_mov_b32 s45, 0xc0c0c0c
  v_cndmask_b32 v13, 0, v6, s[44:45]
  s_mov_b32 s44, 0x30303030
  s_mov_b32 s45, 0x30303030
  v_cndmask_b32 v14, 0, v6, s[44:45]
  s_mov_b32 s44, 0xc0c0c0c0
  s_mov_b32 s45, 0xc0c0c0c0
  v_cndmask_b32 v15, 0, v6, s[44:45]
  v_lshrrev_b32 v6, 1, v1
  v_and_b32 v7, 1, v1
  v_lshl_add_u32 v6, v7, 1, v6
  v_lshl_add_u32 v6, v2, 2, v6
  v_lshlrev_b32 v231, 4, v6
  s_lshl_b32 s42, s6, 10
  s_add_u32 s42, s42, 2097152
  s_and_b32 s41, s42, 0xffffe000
  s_waitcnt vmcnt(20)
  v_lshlrev_b32 v24, 16, v16
  v_and_b32 v25, 0xffff0000, v16
  v_lshlrev_b32 v26, 16, v17
  v_and_b32 v27, 0xffff0000, v17
  v_lshlrev_b32 v28, 16, v18
  v_and_b32 v29, 0xffff0000, v18
  v_lshlrev_b32 v30, 16, v19
  v_and_b32 v31, 0xffff0000, v19
  v_lshlrev_b32 v32, 16, v20
  v_and_b32 v33, 0xffff0000, v20
  v_add_f32 v34, v24, v25
  v_add_f32 v34, v34, v26
  v_add_f32 v34, v34, v27
  v_add_f32 v34, v34, v28
  v_add_f32 v34, v34, v29
  v_add_f32 v34, v34, v30
  v_add_f32 v34, v34, v31
  v_add_f32 v34, v34, v32
  v_add_f32 v34, v34, v33
  s_nop 1
  v_add_f32_dpp v34, v34, v34 row_ror:1 row_mask:0xf bank_mask:0xf
  s_nop 1
  v_add_f32_dpp v34, v34, v34 row_ror:2 row_mask:0xf bank_mask:0xf
  s_nop 1
  v_add_f32_dpp v34, v34, v34 row_ror:4 row_mask:0xf bank_mask:0xf
  s_nop 1
  v_add_f32_dpp v34, v34, v34 row_ror:8 row_mask:0xf bank_mask:0xf
  v_mov_b32 v16, v34
  s_nop 1
  v_permlane16_swap_b32 v34, v16
  s_nop 0
  v_add_f32 v34, v34, v16
  v_mov_b32 v16, v34
  s_nop 1
  v_permlane32_swap_b32 v34, v16
  s_nop 0
  v_add_f32 v34, v34, v16
  v_mul_f32 v34, 0x3acccccd, v34
  v_sub_f32 v16, v24, v34
  v_mul_f32 v35, v16, v16
  v_sub_f32 v16, v25, v34
  v_fmac_f32 v35, v16, v16
  v_sub_f32 v16, v26, v34
  v_fmac_f32 v35, v16, v16
  v_sub_f32 v16, v27, v34
  v_fmac_f32 v35, v16, v16
  v_sub_f32 v16, v28, v34
  v_fmac_f32 v35, v16, v16
  v_sub_f32 v16, v29, v34
  v_fmac_f32 v35, v16, v16
  v_sub_f32 v16, v30, v34
  v_fmac_f32 v35, v16, v16
  v_sub_f32 v16, v31, v34
  v_fmac_f32 v35, v16, v16
  v_sub_f32 v16, v32, v34
  v_fmac_f32 v35, v16, v16
  v_sub_f32 v16, v33, v34
  v_fmac_f32 v35, v16, v16
  s_nop 1
  v_add_f32_dpp v35, v35, v35 row_ror:1 row_mask:0xf bank_mask:0xf
  s_nop 1
  v_add_f32_dpp v35, v35, v35 row_ror:2 row_mask:0xf bank_mask:0xf
  s_nop 1
  v_add_f32_dpp v35, v35, v35 row_ror:4 row_mask:0xf bank_mask:0xf
  s_nop 1
  v_add_f32_dpp v35, v35, v35 row_ror:8 row_mask:0xf bank_mask:0xf
  v_mov_b32 v16, v35
  s_nop 1
  v_permlane16_swap_b32 v35, v16
  s_nop 0
  v_add_f32 v35, v35, v16
  v_mov_b32 v16, v35
  s_nop 1
  v_permlane32_swap_b32 v35, v16
  s_nop 0
  v_add_f32 v35, v35, v16
  v_mul_f32 v35, 0x3acccccd, v35
  v_cvt_pk_bf16_f32 v34, v34, v34
  v_and_b32 v34, 0xffff0000, v34
  v_cvt_pk_bf16_f32 v35, v35, v35
  v_and_b32 v35, 0xffff0000, v35
  v_add_f32 v35, 0x3727c5ac, v35
  v_cvt_pk_bf16_f32 v35, v35, v35
  v_and_b32 v35, 0xffff0000, v35
  v_sqrt_f32 v35, v35
  s_nop 0
  v_cvt_pk_bf16_f32 v35, v35, v35
  v_and_b32 v35, 0xffff0000, v35
  v_rcp_f32 v35, v35
  s_nop 0
  v_lshlrev_b32 v21, 16, v21
  v_lshlrev_b32 v22, 16, v22
  v_sub_f32 v21, v21, v34
  v_cvt_pk_bf16_f32 v21, v21, v21
  v_and_b32 v21, 0xffff0000, v21
  v_mul_f32 v21, v21, v35
  v_cvt_pk_bf16_f32 v21, v21, v21
  v_sub_f32 v22, v22, v34
  v_cvt_pk_bf16_f32 v22, v22, v22
  v_and_b32 v22, 0xffff0000, v22
  v_mul_f32 v22, v22, v35
  v_cvt_pk_bf16_f32 v22, v22, v22
  s_nop 1
  v_and_b32_dpp v24, v21, v12 row_newbcast:0 row_mask:0xf bank_mask:0xf
  v_and_b32_dpp v25, v21, v13 row_newbcast:0 row_mask:0xf bank_mask:0xf
  v_and_b32_dpp v26, v21, v14 row_newbcast:0 row_mask:0xf bank_mask:0xf
  v_and_b32_dpp v27, v21, v15 row_newbcast:0 row_mask:0xf bank_mask:0xf
  s_waitcnt vmcnt(19)
  s_nop 0
  v_mfma_f32_16x16x32_bf16 v[28:31], v[24:27], v[64:67], 0
  v_and_b32_dpp v24, v21, v12 row_newbcast:1 row_mask:0xf bank_mask:0xf
  v_and_b32_dpp v25, v21, v13 row_newbcast:1 row_mask:0xf bank_mask:0xf
  v_and_b32_dpp v26, v21, v14 row_newbcast:1 row_mask:0xf bank_mask:0xf
  v_and_b32_dpp v27, v21, v15 row_newbcast:1 row_mask:0xf bank_mask:0xf
  s_waitcnt vmcnt(18)
  s_nop 0
  v_mfma_f32_16x16x32_bf16 v[28:31], v[24:27], v[68:71], v[28:31]
  v_and_b32_dpp v24, v21, v12 row_newbcast:2 row_mask:0xf bank_mask:0xf
  v_and_b32_dpp v25, v21, v13 row_newbcast:2 row_mask:0xf bank_mask:0xf
  v_and_b32_dpp v26, v21, v14 row_newbcast:2 row_mask:0xf bank_mask:0xf
  v_and_b32_dpp v27, v21, v15 row_newbcast:2 row_mask:0xf bank_mask:0xf
  s_waitcnt vmcnt(17)
  s_nop 0
  v_mfma_f32_16x16x32_bf16 v[28:31], v[24:27], v[72:75], v[28:31]
  v_and_b32_dpp v24, v21, v12 row_newbcast:3 row_mask:0xf bank_mask:0xf
  v_and_b32_dpp v25, v21, v13 row_newbcast:3 row_mask:0xf bank_mask:0xf
  v_and_b32_dpp v26, v21, v14 row_newbcast:3 row_mask:0xf bank_mask:0xf
  v_and_b32_dpp v27, v21, v15 row_newbcast:3 row_mask:0xf bank_mask:0xf
  s_waitcnt vmcnt(16)
  s_nop 0
  v_mfma_f32_16x16x32_bf16 v[28:31], v[24:27], v[76:79], v[28:31]
  v_and_b32_dpp v24, v21, v12 row_newbcast:4 row_mask:0xf bank_mask:0xf
  v_and_b32_dpp v25, v21, v13 row_newbcast:4 row_mask:0xf bank_mask:0xf
  v_and_b32_dpp v26, v21, v14 row_newbcast:4 row_mask:0xf bank_mask:0xf
  v_and_b32_dpp v27, v21, v15 row_newbcast:4 row_mask:0xf bank_mask:0xf
  s_waitcnt vmcnt(15)
  s_nop 0
  v_mfma_f32_16x16x32_bf16 v[28:31], v[24:27], v[80:83], v[28:31]
  v_and_b32_dpp v24, v21, v12 row_newbcast:5 row_mask:0xf bank_mask:0xf
  v_and_b32_dpp v25, v21, v13 row_newbcast:5 row_mask:0xf bank_mask:0xf
  v_and_b32_dpp v26, v21, v14 row_newbcast:5 row_mask:0xf bank_mask:0xf
  v_and_b32_dpp v27, v21, v15 row_newbcast:5 row_mask:0xf bank_mask:0xf
  s_waitcnt vmcnt(14)
  s_nop 0
  v_mfma_f32_16x16x32_bf16 v[28:31], v[24:27], v[84:87], v[28:31]
  v_and_b32_dpp v24, v21, v12 row_newbcast:6 row_mask:0xf bank_mask:0xf
  v_and_b32_dpp v25, v21, v13 row_newbcast:6 row_mask:0xf bank_mask:0xf
  v_and_b32_dpp v26, v21, v14 row_newbcast:6 row_mask:0xf bank_mask:0xf
  v_and_b32_dpp v27, v21, v15 row_newbcast:6 row_mask:0xf bank_mask:0xf
  s_waitcnt vmcnt(13)
  s_nop 0
  v_mfma_f32_16x16x32_bf16 v[28:31], v[24:27], v[88:91], v[28:31]
  v_and_b32_dpp v24, v21, v12 row_newbcast:7 row_mask:0xf bank_mask:0xf
  v_and_b32_dpp v25, v21, v13 row_newbcast:7 row_mask:0xf bank_mask:0xf
  v_and_b32_dpp v26, v21, v14 row_newbcast:7 row_mask:0xf bank_mask:0xf
  v_and_b32_dpp v27, v21, v15 row_newbcast:7 row_mask:0xf bank_mask:0xf
  s_waitcnt vmcnt(12)
  s_nop 0
  v_mfma_f32_16x16x32_bf16 v[28:31], v[24:27], v[92:95], v[28:31]
  v_and_b32_dpp v24, v21, v12 row_newbcast:8 row_mask:0xf bank_mask:0xf
  v_and_b32_dpp v25, v21, v13 row_newbcast:8 row_mask:0xf bank_mask:0xf
  v_and_b32_dpp v26, v21, v14 row_newbcast:8 row_mask:0xf bank_mask:0xf
  v_and_b32_dpp v27, v21, v15 row_newbcast:8 row_mask:0xf bank_mask:0xf
  s_waitcnt vmcnt(11)
  s_nop 0
  v_mfma_f32_16x16x32_bf16 v[28:31], v[24:27], v[96:99], v[28:31]
  v_and_b32_dpp v24, v21, v12 row_newbcast:9 row_mask:0xf bank_mask:0xf
  v_and_b32_dpp v25, v21, v13 row_newbcast:9 row_mask:0xf bank_mask:0xf
  v_and_b32_dpp v26, v21, v14 row_newbcast:9 row_mask:0xf bank_mask:0xf
  v_and_b32_dpp v27, v21, v15 row_newbcast:9 row_mask:0xf bank_mask:0xf
  s_waitcnt vmcnt(10)
  s_nop 0
  v_mfma_f32_16x16x32_bf16 v[28:31], v[24:27], v[100:103], v[28:31]
  v_and_b32_dpp v24, v21, v12 row_newbcast:10 row_mask:0xf bank_mask:0xf
  v_and_b32_dpp v25, v21, v13 row_newbcast:10 row_mask:0xf bank_mask:0xf
  v_and_b32_dpp v26, v21, v14 row_newbcast:10 row_mask:0xf bank_mask:0xf
  v_and_b32_dpp v27, v21, v15 row_newbcast:10 row_mask:0xf bank_mask:0xf
  s_waitcnt vmcnt(9)
  s_nop 0
  v_mfma_f32_16x16x32_bf16 v[28:31], v[24:27], v[104:107], v[28:31]
  v_and_b32_dpp v24, v21, v12 row_newbcast:11 row_mask:0xf bank_mask:0xf
  v_and_b32_dpp v25, v21, v13 row_newbcast:11 row_mask:0xf bank_mask:0xf
  v_and_b32_dpp v26, v21, v14 row_newbcast:11 row_mask:0xf bank_mask:0xf
  v_and_b32_dpp v27, v21, v15 row_newbcast:11 row_mask:0xf bank_mask:0xf
  s_waitcnt vmcnt(8)
  s_nop 0
  v_mfma_f32_16x16x32_bf16 v[28:31], v[24:27], v[108:111], v[28:31]
  v_and_b32_dpp v24, v21, v12 row_newbcast:12 row_mask:0xf bank_mask:0xf
  v_and_b32_dpp v25, v21, v13 row_newbcast:12 row_mask:0xf bank_mask:0xf
  v_and_b32_dpp v26, v21, v14 row_newbcast:12 row_mask:0xf bank_mask:0xf
  v_and_b32_dpp v27, v21, v15 row_newbcast:12 row_mask:0xf bank_mask:0xf
  s_waitcnt vmcnt(7)
  s_nop 0
  v_mfma_f32_16x16x32_bf16 v[28:31], v[24:27], v[112:115], v[28:31]
  v_and_b32_dpp v24, v21, v12 row_newbcast:13 row_mask:0xf bank_mask:0xf
  v_and_b32_dpp v25, v21, v13 row_newbcast:13 row_mask:0xf bank_mask:0xf
  v_and_b32_dpp v26, v21, v14 row_newbcast:13 row_mask:0xf bank_mask:0xf
  v_and_b32_dpp v27, v21, v15 row_newbcast:13 row_mask:0xf bank_mask:0xf
  s_waitcnt vmcnt(6)
  s_nop 0
  v_mfma_f32_16x16x32_bf16 v[28:31], v[24:27], v[116:119], v[28:31]
  v_and_b32_dpp v24, v21, v12 row_newbcast:14 row_mask:0xf bank_mask:0xf
  v_and_b32_dpp v25, v21, v13 row_newbcast:14 row_mask:0xf bank_mask:0xf
  v_and_b32_dpp v26, v21, v14 row_newbcast:14 row_mask:0xf bank_mask:0xf
  v_and_b32_dpp v27, v21, v15 row_newbcast:14 row_mask:0xf bank_mask:0xf
  s_waitcnt vmcnt(5)
  s_nop 0
  v_mfma_f32_16x16x32_bf16 v[28:31], v[24:27], v[120:123], v[28:31]
  v_and_b32_dpp v24, v21, v12 row_newbcast:15 row_mask:0xf bank_mask:0xf
  v_and_b32_dpp v25, v21, v13 row_newbcast:15 row_mask:0xf bank_mask:0xf
  v_and_b32_dpp v26, v21, v14 row_newbcast:15 row_mask:0xf bank_mask:0xf
  v_and_b32_dpp v27, v21, v15 row_newbcast:15 row_mask:0xf bank_mask:0xf
  s_waitcnt vmcnt(4)
  s_nop 0
  v_mfma_f32_16x16x32_bf16 v[28:31], v[24:27], v[124:127], v[28:31]
  v_and_b32_dpp v24, v22, v12 row_newbcast:0 row_mask:0xf bank_mask:0xf
  v_and_b32_dpp v25, v22, v13 row_newbcast:0 row_mask:0xf bank_mask:0xf
  v_and_b32_dpp v26, v22, v14 row_newbcast:0 row_mask:0xf bank_mask:0xf
  v_and_b32_dpp v27, v22, v15 row_newbcast:0 row_mask:0xf bank_mask:0xf
  s_waitcnt vmcnt(3)
  s_nop 0
  v_mfma_f32_16x16x32_bf16 v[28:31], v[24:27], v[128:131], v[28:31]
  v_and_b32_dpp v24, v22, v12 row_newbcast:1 row_mask:0xf bank_mask:0xf
  v_and_b32_dpp v25, v22, v13 row_newbcast:1 row_mask:0xf bank_mask:0xf
  v_and_b32_dpp v26, v22, v14 row_newbcast:1 row_mask:0xf bank_mask:0xf
  v_and_b32_dpp v27, v22, v15 row_newbcast:1 row_mask:0xf bank_mask:0xf
  s_waitcnt vmcnt(2)
  s_nop 0
  v_mfma_f32_16x16x32_bf16 v[28:31], v[24:27], v[132:135], v[28:31]
  v_and_b32_dpp v24, v22, v12 row_newbcast:2 row_mask:0xf bank_mask:0xf
  v_and_b32_dpp v25, v22, v13 row_newbcast:2 row_mask:0xf bank_mask:0xf
  v_and_b32_dpp v26, v22, v14 row_newbcast:2 row_mask:0xf bank_mask:0xf
  v_and_b32_dpp v27, v22, v15 row_newbcast:2 row_mask:0xf bank_mask:0xf
  s_waitcnt vmcnt(1)
  s_nop 0
  v_mfma_f32_16x16x32_bf16 v[28:31], v[24:27], v[136:139], v[28:31]
  v_and_b32_dpp v24, v22, v12 row_newbcast:3 row_mask:0xf bank_mask:0xf
  v_and_b32_dpp v25, v22, v13 row_newbcast:3 row_mask:0xf bank_mask:0xf
  v_and_b32_dpp v26, v22, v14 row_newbcast:3 row_mask:0xf bank_mask:0xf
  v_and_b32_dpp v27, v22, v15 row_newbcast:3 row_mask:0xf bank_mask:0xf
  s_waitcnt vmcnt(0)
  s_nop 0
  v_mfma_f32_16x16x32_bf16 v[28:31], v[24:27], v[140:143], v[28:31]
  s_waitcnt lgkmcnt(0)
  s_lshr_b32 s54, s54, 4
  s_mul_i32 s54, s54, 0x9e3779b1
  s_add_u32 s54, s54, 0x7f4a7c15
  s_lshl_b32 s54, s54, 4
  s_getreg_b32 s47, hwreg(HW_REG_XCC_ID, 0, 4)
  s_or_b32 s47, s47, s54
  s_mov_b32 s44, 0
  s_mov_b32 s45, -1
  v_mov_b32 v25, s47
  v_mov_b32 v27, s47
  v_cndmask_b32 v24, v28, v30, s[44:45]
  v_cndmask_b32 v26, v29, v31, s[44:45]
  buffer_store_dwordx4 v[24:27], v231, s[48:51], s42 offen
  s_add_u32 s42, s42, 262144
  s_waitcnt vmcnt(0)
  s_mov_b32 s47, 0
L_q_x:
  s_cmp_lt_u32 s47, 6
  s_cbranch_scc1 L_q_keep
  s_xor_b32 s41, s41, 262144
  s_cmp_eq_u32 s47, 6
  s_cbranch_scc0 L_q_keep
  buffer_store_dwordx4 v[24:27], v231, s[48:51], s42 offen sc1
L_q_keep:
  s_add_u32 s43, s41, 4096
  buffer_load_dwordx4 v[160:163], v228, s[48:51], s41 offen offset:0 sc1 nt
  buffer_load_dwordx4 v[164:167], v228, s[48:51], s41 offen offset:1024 sc1 nt
  buffer_load_dwordx4 v[168:171], v228, s[48:51], s41 offen offset:2048 sc1 nt
  buffer_load_dwordx4 v[172:175], v228, s[48:51], s41 offen offset:3072 sc1 nt
  buffer_load_dwordx4 v[176:179], v228, s[48:51], s43 offen offset:0 sc1 nt
  buffer_load_dwordx4 v[180:183], v228, s[48:51], s43 offen offset:1024 sc1 nt
  buffer_load_dwordx4 v[184:187], v228, s[48:51], s43 offen offset:2048 sc1 nt
  buffer_load_dwordx4 v[188:191], v228, s[48:51], s43 offen offset:3072 sc1 nt
  s_waitcnt vmcnt(7)
  v_and_b32 v6, v161, v163
  v_or_b32 v7, v161, v163
  s_waitcnt vmcnt(6)
  v_bitop3_b32 v6, v6, v165, v167 bitop3:0x80
  v_or3_b32 v7, v7, v165, v167
  v_add_f32 v160, v160, v164
  v_add_f32 v162, v162, v166
  s_waitcnt vmcnt(5)
  v_bitop3_b32 v6, v6, v169, v171 bitop3:0x80
  v_or3_b32 v7, v7, v169, v171
  v_add_f32 v160, v160, v168
  v_add_f32 v162, v162, v170
  s_waitcnt vmcnt(4)
  v_bitop3_b32 v6, v6, v173, v175 bitop3:0x80
  v_or3_b32 v7, v7, v173, v175
  v_add_f32 v160, v160, v172
  v_add_f32 v162, v162, v174
  s_waitcnt vmcnt(3)
  v_bitop3_b32 v6, v6, v177, v179 bitop3:0x80
  v_or3_b32 v7, v7, v177, v179
  v_add_f32 v160, v160, v176
  v_add_f32 v162, v162, v178
  s_waitcnt vmcnt(2)
  v_bitop3_b32 v6, v6, v181, v183 bitop3:0x80
  v_or3_b32 v7, v7, v181, v183
  v_add_f32 v160, v160, v180
  v_add_f32 v162, v162, v182
  s_waitcnt vmcnt(1)
  v_bitop3_b32 v6, v6, v185, v187 bitop3:0x80
  v_or3_b32 v7, v7, v185, v187
  v_add_f32 v160, v160, v184
  v_add_f32 v162, v162, v186
  s_waitcnt vmcnt(0)
  v_bitop3_b32 v6, v6, v189, v191 bitop3:0x80
  v_or3_b32 v7, v7, v189, v191
  v_add_f32 v160, v160, v188
  v_add_f32 v162, v162, v190
  v_xor_b32 v8, s54, v6
  v_xor_b32 v9, s54, v7
  v_cmp_lt_u32 vcc, 15, v8
  v_cmp_lt_u32 s[44:45], 15, v9
  s_add_u32 s47, s47, 1
  s_or_b64 vcc, vcc, s[44:45]
  s_cbranch_scc0 L_q_x_ok
  s_sleep 1
  s_cmp_lt_u32 s47, 0x40000
  s_cbranch_scc1 L_q_x
L_q_x_ok:
  v_xor_b32 v7, v6, v7
  v_cvt_pk_bf16_f32 v8, v160, v162
  ds_write_b32 v3, v8 offset:16640
  v_mov_b32 v6, s54
  v_mov_b32 v8, 0
  ds_write_b64 v8, v[6:7] offset:16928
  v_readfirstlane_b32 s57, v7
  s_cmp_eq_u32 s57, 0
  s_cbranch_scc1 L_q_near
  buffer_store_dwordx4 v[24:27], v231, s[48:51], s42 offen sc1
L_q_near:
  s_waitcnt lgkmcnt(0)
  s_barrier
  s_branch L_h_shadow
L_h_noq:
  s_cmp_eq_u32 s40, 2
  s_cbranch_scc1 L_pad
L_pad_ret:
  s_waitcnt lgkmcnt(0)
  s_mov_b32 s8, s16
  s_mov_b32 s9, s17
  s_mov_b32 s10, 1280
  s_mov_b32 s11, 0x20000
  s_mov_b32 s48, s38
  s_mov_b32 s49, s39
  s_mov_b32 s50, 3145728
  s_mov_b32 s51, 0x20000
  s_cmp_eq_u32 s40, 1
  s_cbranch_scc1 L_ffn
  s_cmp_eq_u32 s40, 3
  s_cbranch_scc0 L_h_shadow
  s_mul_i32 s59, s5, 20480
  s_mul_i32 s41, s4, 640
  s_add_u32 s59, s59, s41
  s_add_u32 s41, s59, 524288
  s_add_u32 s59, s59, 327680
  s_mov_b32 exec_hi, 0xff
  buffer_load_dwordx4 v[8:11], v228, s[48:51], s59 offen
  buffer_load_dwordx4 v[12:15], v228, s[48:51], s41 offen
  s_mov_b64 exec, -1
L_h_shadow:
  v_lshrrev_b32 v6, 1, v1
  v_and_b32 v7, 1, v1
  v_lshl_add_u32 v6, v7, 1, v6
  v_lshl_add_u32 v6, v2, 2, v6
  v_lshlrev_b32 v231, 4, v6
  s_mov_b32 s12, s24
  s_mov_b32 s13, s25
  s_mov_b32 s14, 5242880
  s_mov_b32 s15, 0x20000
  v_mul_u32_u24 v36, 10240, v1
  v_lshl_add_u32 v36, v2, 4, v36
  v_mov_b32 v37, 0x7fffffff
  s_mov_b32 s44, 0x03ff03ff
  s_mov_b32 s45, 0x03ff03ff
  v_cndmask_b32 v239, v37, v36, s[44:45]
  s_lshl_b32 s46, s4, 2
  s_add_u32 s46, s46, s40
  s_mul_i32 s46, s46, 40960
  s_mul_i32 s47, s5, 160
  s_add_u32 s46, s46, s47
  buffer_load_dwordx4 v[64:67], v239, s[12:15], s46 offen offset:0 nt
  buffer_load_dwordx4 v[80:83], v239, s[12:15], s46 offen offset:1280 nt
  s_cmp_lt_u32 s40, 2
  s_cbranch_scc1 L_h_nobar
  s_barrier
  v_mov_b32 v6, 0
  ds_read_b64 v[6:7], v6 offset:16928
  s_waitcnt lgkmcnt(0)
  v_readfirstlane_b32 s54, v6
  v_readfirstlane_b32 s57, v7
L_h_nobar:
  s_waitcnt vmcnt(0)
  v_mov_b32 v227, 0
  s_mov_b32 s55, 0
  s_cmp_eq_u32 s40, 2
  s_cbranch_scc1 L_pacer
  s_cmp_eq_u32 s40, 3
  s_cselect_b32 s41, s2, 0
  s_cmp_ge_u32 s41, 216
  s_cbranch_scc0 L_h_nocons
  s_mov_b32 s55, 1
  s_mov_b32 s60, s34
  s_mov_b32 s61, s35
  s_mov_b32 s62, 1280
  s_mov_b32 s63, 0x20000
  s_sub_u32 s52, s2, 216
  s_lshl_b32 s53, s52, 5
  v_and_b32 v6, 7, v0
  v_lshrrev_b32 v7, 5, v0
  v_lshl_add_u32 v229, v6, 1, v7
  v_lshlrev_b32 v229, 1, v229
  v_lshrrev_b32 v230, 3, v0
  v_mul_u32_u24 v230, 2560, v230
  v_lshl_add_u32 v230, v6, 4, v230
  s_mul_i32 s42, s52, 52
  s_lshr_b32 s42, s42, 8
  s_mul_i32 s42, s42, 19840
  s_lshl_b32 s52, s52, 7
  s_add_u32 s52, s52, s42
  s_add_u32 s56, s52, 524288
  s_add_u32 s52, s52, 327680
  s_mov_b32 s47, 0
L_h_trigA:
  ds_read_b32 v3, v227 offset:16912
  s_waitcnt lgkmcnt(0)
  v_readfirstlane_b32 s42, v3
  s_add_u32 s47, s47, 1
  s_cmp_ge_u32 s42, 1
  s_cbranch_scc1 L_h_trigA_ok
  s_sleep 100
  s_cmp_lt_u32 s47, 0x100000
  s_cbranch_scc1 L_h_trigA
L_h_trigA_ok:
  buffer_load_ushort v225, v229, s[8:11], s53 offen
  s_mov_b32 s47, 0
  buffer_load_dwordx4 v[8:11], v230, s[48:51], s56 offen offset:0 sc1
  buffer_load_dwordx4 v[12:15], v230, s[48:51], s56 offen offset:640 sc1
  buffer_load_dwordx4 v[16:19], v230, s[48:51], s56 offen offset:1280 sc1
  buffer_load_dwordx4 v[20:23], v230, s[48:51], s56 offen offset:1920 sc1
L_c_gp:
  s_waitcnt vmcnt(0)
  v_and_b32 v3, v9, v11
  v_or_b32 v7, v9, v11
  v_bitop3_b32 v3, v3, v13, v15 bitop3:0x80
  v_or3_b32 v7, v7, v13, v15
  v_bitop3_b32 v3, v3, v17, v19 bitop3:0x80
  v_or3_b32 v7, v7, v17, v19
  v_bitop3_b32 v3, v3, v21, v23 bitop3:0x80
  v_or3_b32 v7, v7, v21, v23
  v_cmp_ne_u32 vcc, s54, v3
  v_cmp_ne_u32 s[44:45], s54, v7
  s_add_u32 s47, s47, 1
  s_or_b64 vcc, vcc, s[44:45]
  s_cbranch_scc0 L_c_gp_ok
  s_mov_b64 exec, vcc
  s_sleep 100
  buffer_load_dwordx4 v[8:11], v230, s[48:51], s56 offen offset:0 sc1
  buffer_load_dwordx4 v[12:15], v230, s[48:51], s56 offen offset:640 sc1
  buffer_load_dwordx4 v[16:19], v230, s[48:51], s56 offen offset:1280 sc1
  buffer_load_dwordx4 v[20:23], v230, s[48:51], s56 offen offset:1920 sc1
  s_cmp_lt_u32 s47, 0x40000
  s_cbranch_scc1 L_c_gp
L_c_gp_ok:
  s_mov_b64 exec, -1
  v_add_f32 v8, v8, v12
  v_add_f32 v10, v10, v14
  v_add_f32 v16, v16, v20
  v_add_f32 v18, v18, v22
  v_add_f32 v8, v8, v16
  v_add_f32 v10, v10, v18
  s_nop 1
  v_permlane32_swap_b32 v8, v10
  s_nop 0
  v_add_f32 v8, v8, v10
  s_nop 0
  v_mov_b32 v10, v8
  s_nop 1
  v_permlane16_swap_b32 v8, v10
  s_nop 0
  v_add_f32 v8, v8, v10
  s_nop 1
  v_add_f32_dpp v8, v8, v8 row_ror:8 row_mask:0xf bank_mask:0xf
  v_cvt_pk_bf16_f32 v8, v8, v8
  v_and_b32 v8, 0xffff0000, v8
  v_mul_f32 v9, 0xbfb8aa3b, v8
  v_exp_f32 v9, v9
  s_nop 0
  v_add_f32 v9, 1.0, v9
  v_rcp_f32 v9, v9
  s_nop 0
  v_mul_f32 v8, v8, v9
  v_cvt_pk_bf16_f32 v224, v8, v8
  v_and_b32 v224, 0xffff0000, v224
  s_waitcnt vmcnt(0)
  v_lshlrev_b32 v225, 16, v225
L_h_nocons:
  v_bfe_u32 v6, v0, 3, 2
  v_and_b32 v7, 7, v0
  v_lshlrev_b32 v232, 9, v6
  v_lshl_add_u32 v232, v7, 4, v232
  s_lshl_b32 s7, s40, 7
  v_add_u32 v232, s7, v232
  v_lshlrev_b32 v233, 2, v6
  v_lshl_add_u32 v234, v7, 1, v1
  v_lshlrev_b32 v234, 4, v234
  s_lshl_b32 s58, s6, 10
  s_lshl_b32 s7, s40, 8
  s_add_u32 s58, s58, s7
  s_lshl_b32 s43, s4, 13
  s_add_u32 s43, s43, s7
  v_lshrrev_b32 v6, 2, v2
  v_and_b32 v7, 3, v2
  v_lshlrev_b32 v235, 11, v6
  v_lshl_add_u32 v235, v1, 6, v235
  v_lshl_add_u32 v235, v7, 4, v235
  v_lshlrev_b32 v236, 5, v6
  s_lshl_b32 s41, s4, 7
  s_add_u32 s41, s41, 262144
  v_lshl_add_u32 v237, v2, 1, v1
  s_mul_i32 s7, s40, 320
  v_lshl_add_u32 v237, v237, 4, s7
  v_lshlrev_b32 v238, 3, v0
  s_mul_i32 s59, s5, 20480
  s_mul_i32 s7, s4, 640
  s_add_u32 s59, s59, s7
  s_add_u32 s59, s59, 327680
  v_lshlrev_b32 v4, 2, v0
  s_mov_b32 s47, 0
L_h_trigB:
  ds_read_b128 v[8:11], v227 offset:16912
  s_waitcnt lgkmcnt(0)
  v_min_u32 v8, v8, v9
  v_min3_u32 v8, v8, v10, v11
  s_add_u32 s47, s47, 1
  v_readfirstlane_b32 s42, v8
  s_cmp_ge_u32 s42, 16
  s_cbranch_scc1 L_h_trigB_ok
  s_sleep 3
  s_cmp_lt_u32 s47, 0x100000
  s_cbranch_scc1 L_h_trigB
L_h_trigB_ok:
  s_add_u32 s46, s46, 2560
  buffer_load_dwordx4 v[68:71], v239, s[12:15], s46 offen offset:0 nt
  buffer_load_dwordx4 v[84:87], v239, s[12:15], s46 offen offset:1280 nt
  s_add_u32 s46, s46, 2560
  buffer_load_dwordx4 v[72:75], v239, s[12:15], s46 offen offset:0 nt
  buffer_load_dwordx4 v[88:91], v239, s[12:15], s46 offen offset:1280 nt
  s_add_u32 s46, s46, 2560
  buffer_load_dwordx4 v[76:79], v239, s[12:15], s46 offen offset:0 nt
  buffer_load_dwordx4 v[92:95], v239, s[12:15], s46 offen offset:1280 nt
  ds_read_b128 v[8:11], v227 offset:16896
  ds_read_b32 v19, v233 offset:16896
  ds_read_b32 v12, v4 offset:16960
  ds_read_b32 v13, v4 offset:17216
  ds_read_b32 v14, v4 offset:17472
  ds_read_b32 v15, v4 offset:17728
  s_waitcnt lgkmcnt(0)
  v_max3_f32 v20, v8, v9, v10
  v_max_f32 v20, v20, v11
  v_sub_f32 v19, v19, v20
  v_mul_f32 v19, 0x3fb8aa3b, v19
  v_exp_f32 v19, v19
  s_cmp_eq_u32 s40, 1
  s_cbranch_scc0 L_h_noml
  v_sub_f32 v8, v8, v20
  v_mul_f32 v8, 0x3fb8aa3b, v8
  v_exp_f32 v8, v8
  v_sub_f32 v9, v9, v20
  v_mul_f32 v9, 0x3fb8aa3b, v9
  v_exp_f32 v9, v9
  v_sub_f32 v10, v10, v20
  v_mul_f32 v10, 0x3fb8aa3b, v10
  v_exp_f32 v10, v10
  v_sub_f32 v11, v11, v20
  v_mul_f32 v11, 0x3fb8aa3b, v11
  v_exp_f32 v11, v11
  v_mul_f32 v22, v8, v12
  v_fmac_f32 v22, v9, v13
  v_fmac_f32 v22, v10, v14
  v_fmac_f32 v22, v11, v15
  s_nop 1
  v_add_f32_dpp v22, v22, v22 row_ror:1 row_mask:0xf bank_mask:0xf
  s_nop 1
  v_add_f32_dpp v22, v22, v22 row_ror:2 row_mask:0xf bank_mask:0xf
  s_nop 1
  v_add_f32_dpp v22, v22, v22 row_ror:4 row_mask:0xf bank_mask:0xf
  s_nop 1
  v_add_f32_dpp v22, v22, v22 row_ror:8 row_mask:0xf bank_mask:0xf
  v_mov_b32 v21, v22
  s_nop 1
  v_permlane16_swap_b32 v22, v21
  s_nop 0
  v_add_f32 v22, v22, v21
  v_mov_b32 v21, v22
  s_nop 1
  v_permlane32_swap_b32 v22, v21
  s_nop 0
  v_add_f32 v22, v22, v21
  v_mov_b32 v21, s54
  v_mov_b32 v23, s54
  s_lshl_b32 s7, s6, 4
  s_add_u32 s7, s7, 262144
  s_mov_b64 exec, 1
  s_cmp_eq_u32 s57, 0
  s_cbranch_scc0 L_ml_far
  buffer_store_dwordx4 v[20:23], off, s[48:51], s7
  s_branch L_ml_fin
L_ml_far:
  buffer_store_dwordx4 v[20:23], off, s[48:51], s7 sc1
L_ml_fin:
  s_mov_b64 exec, -1
L_h_noml:
  v_mov_b32 v41, s54
  v_mov_b32 v43, s54
  s_barrier
  ds_read_b128 v[8:11], v232 offset:17984
  buffer_load_dwordx4 v[24:27], v236, s[48:51], s41 offen offset:0 sc1 nt
  buffer_load_dwordx4 v[28:31], v236, s[48:51], s41 offen offset:16 sc1 nt
  s_waitcnt lgkmcnt(0)
  v_mul_f32 v8, v19, v8
  v_mul_f32 v9, v19, v9
  v_mul_f32 v10, v19, v10
  v_mul_f32 v11, v19, v11
  v_add_f32_dpp v8, v8, v8 row_ror:8 row_mask:0xf bank_mask:0xf
  v_add_f32_dpp v9, v9, v9 row_ror:8 row_mask:0xf bank_mask:0xf
  v_add_f32_dpp v10, v10, v10 row_ror:8 row_mask:0xf bank_mask:0xf
  v_add_f32_dpp v11, v11, v11 row_ror:8 row_mask:0xf bank_mask:0xf
  s_mov_b32 s44, 0x00ff00ff
  s_mov_b32 s45, 0
  v_permlane16_swap_b32 v8, v10
  v_permlane16_swap_b32 v9, v11
  s_nop 0
  v_add_f32 v40, v8, v10
  v_add_f32 v42, v9, v11
  s_mov_b64 exec, s[44:45]
  s_cmp_eq_u32 s57, 0
  s_cbranch_scc0 L_o_far
  buffer_store_dwordx4 v[40:43], v234, s[48:51], s58 offen
  s_branch L_o_fin
L_o_far:
  buffer_store_dwordx4 v[40:43], v234, s[48:51], s58 offen sc1
L_o_fin:
  s_mov_b64 exec, -1
  buffer_load_dwordx4 v[32:35], v235, s[48:51], s43 offen offset:0 sc1 nt
  buffer_load_dwordx4 v[36:39], v235, s[48:51], s43 offen offset:1024 sc1 nt
  s_mov_b32 s47, 0
  s_waitcnt vmcnt(5)
  s_mov_b32 s44, 0x05040100
  s_mov_b32 s45, 0x07060302
  v_perm_b32 v192, v80, v64, s44
  v_perm_b32 v208, v80, v64, s45
  v_perm_b32 v193, v84, v68, s44
  v_perm_b32 v209, v84, v68, s45
  v_perm_b32 v194, v88, v72, s44
  v_perm_b32 v210, v88, v72, s45
  v_perm_b32 v195, v92, v76, s44
  v_perm_b32 v211, v92, v76, s45
  v_perm_b32 v196, v81, v65, s44
  v_perm_b32 v212, v81, v65, s45
  v_perm_b32 v197, v85, v69, s44
  v_perm_b32 v213, v85, v69, s45
  v_perm_b32 v198, v89, v73, s44
  v_perm_b32 v214, v89, v73, s45
  v_perm_b32 v199, v93, v77, s44
  v_perm_b32 v215, v93, v77, s45
  v_perm_b32 v200, v82, v66, s44
  v_perm_b32 v216, v82, v66, s45
  v_perm_b32 v201, v86, v70, s44
  v_perm_b32 v217, v86, v70, s45
  v_perm_b32 v202, v90, v74, s44
  v_perm_b32 v218, v90, v74, s45
  v_perm_b32 v203, v94, v78, s44
  v_perm_b32 v219, v94, v78, s45
  v_perm_b32 v204, v83, v67, s44
  v_perm_b32 v220, v83, v67, s45
  v_perm_b32 v205, v87, v71, s44
  v_perm_b32 v221, v87, v71, s45
  v_perm_b32 v206, v91, v75, s44
  v_perm_b32 v222, v91, v75, s45
  v_perm_b32 v207, v95, v79, s44
  v_perm_b32 v223, v95, v79, s45
  s_waitcnt vmcnt(3)
  v_and_b32 v3, v25, v27
  v_or_b32 v7, v25, v27
  v_bitop3_b32 v3, v3, v29, v31 bitop3:0x80
  v_or3_b32 v7, v7, v29, v31
  v_cmp_ne_u32 vcc, s54, v3
  v_cmp_ne_u32 s[44:45], s54, v7
  s_add_u32 s47, s47, 1
  s_or_b64 vcc, vcc, s[44:45]
  v_max_f32 v18, v24, v28
  s_cbranch_scc1 L_h_mlwait
L_h_mlok:
  s_nop 0
  v_max_f32_dpp v18, v18, v18 row_ror:4 row_mask:0xf bank_mask:0xf
  s_nop 1
  v_max_f32_dpp v18, v18, v18 row_ror:8 row_mask:0xf bank_mask:0xf
  v_sub_f32 v16, v24, v18
  v_sub_f32 v17, v28, v18
  v_mul_f32 v16, 0x3fb8aa3b, v16
  v_mul_f32 v17, 0x3fb8aa3b, v17
  v_exp_f32 v16, v16
  v_exp_f32 v17, v17
  v_mul_f32 v18, v26, v16
  v_fmac_f32 v18, v30, v17
  s_nop 1
  v_add_f32_dpp v18, v18, v18 row_ror:4 row_mask:0xf bank_mask:0xf
  s_nop 1
  v_add_f32_dpp v18, v18, v18 row_ror:8 row_mask:0xf bank_mask:0xf
  v_rcp_f32 v18, v18
  s_mov_b32 s47, 0
  v_mul_f32 v16, v16, v18
  v_mul_f32 v17, v17, v18
L_h_o:
  s_waitcnt vmcnt(0)
  v_and_b32 v3, v33, v35
  v_or_b32 v7, v33, v35
  v_bitop3_b32 v3, v3, v37, v39 bitop3:0x80
  v_or3_b32 v7, v7, v37, v39
  v_cmp_ne_u32 vcc, s54, v3
  v_cmp_ne_u32 s[44:45], s54, v7
  s_add_u32 s47, s47, 1
  s_or_b64 vcc, vcc, s[44:45]
  s_cbranch_scc0 L_h_o_ok
  s_mov_b64 exec, vcc
  buffer_load_dwordx4 v[32:35], v235, s[48:51], s43 offen offset:0 sc1 nt
  buffer_load_dwordx4 v[36:39], v235, s[48:51], s43 offen offset:1024 sc1 nt
  s_cmp_lt_u32 s47, 0x40000
  s_cbranch_scc1 L_h_o
L_h_o_ok:
  s_mov_b64 exec, -1
  v_mul_f32 v32, v16, v32
  v_mul_f32 v34, v16, v34
  v_fmac_f32 v32, v17, v36
  v_fmac_f32 v34, v17, v38
  s_nop 0
  v_add_f32_dpp v32, v32, v32 row_ror:4 row_mask:0xf bank_mask:0xf
  v_add_f32_dpp v34, v34, v34 row_ror:4 row_mask:0xf bank_mask:0xf
  s_nop 0
  v_add_f32_dpp v32, v32, v32 row_ror:8 row_mask:0xf bank_mask:0xf
  v_add_f32_dpp v34, v34, v34 row_ror:8 row_mask:0xf bank_mask:0xf
  v_cvt_pk_bf16_f32 v32, v32, v34
  s_mov_b32 s44, 0xffff0000
  s_mov_b32 s45, 0xffff0000
  v_mov_b32_dpp v28, v32 quad_perm:[0,0,0,0] row_mask:0xf bank_mask:0xf
  v_mov_b32_dpp v29, v32 quad_perm:[1,1,1,1] row_mask:0xf bank_mask:0xf
  v_mov_b32_dpp v30, v32 quad_perm:[2,2,2,2] row_mask:0xf bank_mask:0xf
  v_mov_b32_dpp v31, v32 quad_perm:[3,3,3,3] row_mask:0xf bank_mask:0xf
  s_nop 1
  v_mfma_f32_16x16x32_bf16 v[96:99], v[28:31], v[192:195], 0
  v_mfma_f32_16x16x32_bf16 v[112:115], v[28:31], v[200:203], 0
  v_mfma_f32_16x16x32_bf16 v[100:103], v[28:31], v[208:211], 0
  v_mfma_f32_16x16x32_bf16 v[116:119], v[28:31], v[216:219], 0
  v_mfma_f32_16x16x32_bf16 v[104:107], v[28:31], v[196:199], 0
  v_mfma_f32_16x16x32_bf16 v[120:123], v[28:31], v[204:207], 0
  v_mfma_f32_16x16x32_bf16 v[108:111], v[28:31], v[212:215], 0
  v_mfma_f32_16x16x32_bf16 v[124:127], v[28:31], v[220:223], 0
  s_mov_b32 exec_lo, 0x03ff03ff
  s_mov_b32 exec_hi, 0
  v_cndmask_b32 v20, v96, v112, s[44:45]
  s_nop 0
  v_cndmask_b32 v21, v100, v116, s[44:45]
  s_nop 0
  v_cndmask_b32 v22, v104, v120, s[44:45]
  s_nop 0
  v_cndmask_b32 v23, v108, v124, s[44:45]
  ds_write_b128 v237, v[20:23] offset:20032
  s_mov_b64 exec, -1
  s_waitcnt lgkmcnt(0)
  s_barrier
  s_cmp_eq_u32 s40, 0
  s_cbranch_scc0 L_h_nou
  ds_read_b64 v[8:9], v238 offset:20032
  ds_read_b64 v[10:11], v238 offset:20352
  ds_read_b64 v[12:13], v238 offset:20672
  ds_read_b64 v[14:15], v238 offset:20992
  s_mov_b32 exec_lo, -1
  s_mov_b32 exec_hi, 0xff
  s_waitcnt lgkmcnt(2)
  v_add_f32 v8, v8, v10
  v_add_f32 v9, v9, v11
  s_waitcnt lgkmcnt(0)
  v_add_f32 v12, v12, v14
  v_add_f32 v13, v13, v15
  v_add_f32 v40, v8, v12
  v_add_f32 v42, v9, v13
  buffer_store_dwordx4 v[40:43], v228, s[48:51], s59 offen sc1
L_h_nou:
  s_cmp_eq_u32 s55, 1
  s_cbranch_scc0 L_h_end
  s_mov_b32 s47, 0
  buffer_load_dwordx4 v[128:131], v230, s[48:51], s52 offen offset:0 sc1
  buffer_load_dwordx4 v[132:135], v230, s[48:51], s52 offen offset:640 sc1
  buffer_load_dwordx4 v[136:139], v230, s[48:51], s52 offen offset:1280 sc1
  buffer_load_dwordx4 v[140:143], v230, s[48:51], s52 offen offset:1920 sc1
  s_sleep 2
  buffer_load_dwordx4 v[144:147], v230, s[48:51], s52 offen offset:0 sc1
  buffer_load_dwordx4 v[148:151], v230, s[48:51], s52 offen offset:640 sc1
  buffer_load_dwordx4 v[152:155], v230, s[48:51], s52 offen offset:1280 sc1
  buffer_load_dwordx4 v[156:159], v230, s[48:51], s52 offen offset:1920 sc1
  s_sleep 2
  buffer_load_dwordx4 v[160:163], v230, s[48:51], s52 offen offset:0 sc1
  buffer_load_dwordx4 v[164:167], v230, s[48:51], s52 offen offset:640 sc1
  buffer_load_dwordx4 v[168:171], v230, s[48:51], s52 offen offset:1280 sc1
  buffer_load_dwordx4 v[172:175], v230, s[48:51], s52 offen offset:1920 sc1
L_c_u:
  s_waitcnt vmcnt(8)
  v_and_b32 v3, v129, v131
  v_or_b32 v7, v129, v131
  v_bitop3_b32 v3, v3, v133, v135 bitop3:0x80
  v_or3_b32 v7, v7, v133, v135
  v_bitop3_b32 v3, v3, v137, v139 bitop3:0x80
  v_or3_b32 v7, v7, v137, v139
  v_bitop3_b32 v3, v3, v141, v143 bitop3:0x80
  v_or3_b32 v7, v7, v141, v143
  v_cmp_ne_u32 vcc, s54, v3
  v_cmp_ne_u32 s[44:45], s54, v7
  s_add_u32 s47, s47, 1
  s_or_b64 vcc, vcc, s[44:45]
  s_cbranch_scc0 L_c_u0
  buffer_load_dwordx4 v[128:131], v230, s[48:51], s52 offen offset:0 sc1
  buffer_load_dwordx4 v[132:135], v230, s[48:51], s52 offen offset:640 sc1
  buffer_load_dwordx4 v[136:139], v230, s[48:51], s52 offen offset:1280 sc1
  buffer_load_dwordx4 v[140:143], v230, s[48:51], s52 offen offset:1920 sc1
  s_waitcnt vmcnt(8)
  v_and_b32 v3, v145, v147
  v_or_b32 v7, v145, v147
  v_bitop3_b32 v3, v3, v149, v151 bitop3:0x80
  v_or3_b32 v7, v7, v149, v151
  v_bitop3_b32 v3, v3, v153, v155 bitop3:0x80
  v_or3_b32 v7, v7, v153, v155
  v_bitop3_b32 v3, v3, v157, v159 bitop3:0x80
  v_or3_b32 v7, v7, v157, v159
  v_cmp_ne_u32 vcc, s54, v3
  v_cmp_ne_u32 s[44:45], s54, v7
  s_add_u32 s47, s47, 1
  s_or_b64 vcc, vcc, s[44:45]
  s_cbranch_scc0 L_c_u1
  buffer_load_dwordx4 v[144:147], v230, s[48:51], s52 offen offset:0 sc1
  buffer_load_dwordx4 v[148:151], v230, s[48:51], s52 offen offset:640 sc1
  buffer_load_dwordx4 v[152:155], v230, s[48:51], s52 offen offset:1280 sc1
  buffer_load_dwordx4 v[156:159], v230, s[48:51], s52 offen offset:1920 sc1
  s_waitcnt vmcnt(8)
  v_and_b32 v3, v161, v163
  v_or_b32 v7, v161, v163
  v_bitop3_b32 v3, v3, v165, v167 bitop3:0x80
  v_or3_b32 v7, v7, v165, v167
  v_bitop3_b32 v3, v3, v169, v171 bitop3:0x80
  v_or3_b32 v7, v7, v169, v171
  v_bitop3_b32 v3, v3, v173, v175 bitop3:0x80
  v_or3_b32 v7, v7, v173, v175
  v_cmp_ne_u32 vcc, s54, v3
  v_cmp_ne_u32 s[44:45], s54, v7
  s_add_u32 s47, s47, 1
  s_or_b64 vcc, vcc, s[44:45]
  s_cbranch_scc0 L_c_u2
  buffer_load_dwordx4 v[160:163], v230, s[48:51], s52 offen offset:0 sc1
  buffer_load_dwordx4 v[164:167], v230, s[48:51], s52 offen offset:640 sc1
  buffer_load_dwordx4 v[168:171], v230, s[48:51], s52 offen offset:1280 sc1
  buffer_load_dwordx4 v[172:175], v230, s[48:51], s52 offen offset:1920 sc1
  s_cmp_lt_u32 s47, 0x40000
  s_cbranch_scc1 L_c_u
L_c_u2:
  v_add_f32 v160, v160, v164
  v_add_f32 v162, v162, v166
  v_add_f32 v168, v168, v172
  v_add_f32 v170, v170, v174
  v_add_f32 v160, v160, v168
  v_add_f32 v162, v162, v170
  s_nop 1
  v_permlane32_swap_b32 v160, v162
  s_nop 0
  v_add_f32 v160, v160, v162
  s_nop 0
  v_mov_b32 v162, v160
  s_nop 1
  v_permlane16_swap_b32 v160, v162
  s_nop 0
  v_add_f32 v160, v160, v162
  s_nop 1
  v_add_f32_dpp v160, v160, v160 row_ror:8 row_mask:0xf bank_mask:0xf
  v_cvt_pk_bf16_f32 v24, v160, v160
  v_and_b32 v24, 0xffff0000, v24
  v_mul_f32 v24, v24, v224
  v_cvt_pk_bf16_f32 v24, v24, v24
  v_and_b32 v24, 0xffff0000, v24
  v_add_f32 v24, v24, v225
  v_cvt_pk_bf16_f32 v24, v24, v24
  s_mov_b32 exec_lo, 0xff
  s_mov_b32 exec_hi, 0xff
  buffer_store_short v24, v229, s[60:63], s53 offen
  s_branch L_c_fin
L_c_u1:
  v_add_f32 v144, v144, v148
  v_add_f32 v146, v146, v150
  v_add_f32 v152, v152, v156
  v_add_f32 v154, v154, v158
  v_add_f32 v144, v144, v152
  v_add_f32 v146, v146, v154
  s_nop 1
  v_permlane32_swap_b32 v144, v146
  s_nop 0
  v_add_f32 v144, v144, v146
  s_nop 0
  v_mov_b32 v146, v144
  s_nop 1
  v_permlane16_swap_b32 v144, v146
  s_nop 0
  v_add_f32 v144, v144, v146
  s_nop 1
  v_add_f32_dpp v144, v144, v144 row_ror:8 row_mask:0xf bank_mask:0xf
  v_cvt_pk_bf16_f32 v24, v144, v144
  v_and_b32 v24, 0xffff0000, v24
  v_mul_f32 v24, v24, v224
  v_cvt_pk_bf16_f32 v24, v24, v24
  v_and_b32 v24, 0xffff0000, v24
  v_add_f32 v24, v24, v225
  v_cvt_pk_bf16_f32 v24, v24, v24
  s_mov_b32 exec_lo, 0xff
  s_mov_b32 exec_hi, 0xff
  buffer_store_short v24, v229, s[60:63], s53 offen
  s_branch L_c_fin
L_c_u0:
  v_add_f32 v128, v128, v132
  v_add_f32 v130, v130, v134
  v_add_f32 v136, v136, v140
  v_add_f32 v138, v138, v142
  v_add_f32 v128, v128, v136
  v_add_f32 v130, v130, v138
  s_nop 1
  v_permlane32_swap_b32 v128, v130
  s_nop 0
  v_add_f32 v128, v128, v130
  s_nop 0
  v_mov_b32 v130, v128
  s_nop 1
  v_permlane16_swap_b32 v128, v130
  s_nop 0
  v_add_f32 v128, v128, v130
  s_nop 1
  v_add_f32_dpp v128, v128, v128 row_ror:8 row_mask:0xf bank_mask:0xf
  v_cvt_pk_bf16_f32 v24, v128, v128
  v_and_b32 v24, 0xffff0000, v24
  v_mul_f32 v24, v24, v224
  v_cvt_pk_bf16_f32 v24, v24, v24
  v_and_b32 v24, 0xffff0000, v24
  v_add_f32 v24, v24, v225
  v_cvt_pk_bf16_f32 v24, v24, v24
  s_mov_b32 exec_lo, 0xff
  s_mov_b32 exec_hi, 0xff
  buffer_store_short v24, v229, s[60:63], s53 offen
L_c_fin:
  s_cmp_eq_u32 s2, 216
  s_cbranch_scc0 L_h_end
  s_mov_b32 s47, 0xfc000
  s_mov_b64 exec, 1
  buffer_store_dword v41, off, s[48:51], s47 sc1
L_h_end:
  s_endpgm
L_h_mlwait:
  s_mov_b32 s47, 0
  buffer_load_dwordx4 v[24:27], v236, s[48:51], s41 offen offset:0 sc1 nt
  buffer_load_dwordx4 v[28:31], v236, s[48:51], s41 offen offset:16 sc1 nt
L_h_ml:
  s_waitcnt vmcnt(0)
  v_and_b32 v3, v25, v27
  v_or_b32 v7, v25, v27
  v_bitop3_b32 v3, v3, v29, v31 bitop3:0x80
  v_or3_b32 v7, v7, v29, v31
  v_cmp_ne_u32 vcc, s54, v3
  v_cmp_ne_u32 s[44:45], s54, v7
  s_add_u32 s47, s47, 1
  s_or_b64 vcc, vcc, s[44:45]
  s_cbranch_scc0 L_h_ml_ok
  s_mov_b64 exec, vcc
  s_sleep 8
  buffer_load_dwordx4 v[24:27], v236, s[48:51], s41 offen offset:0 sc1 nt
  buffer_load_dwordx4 v[28:31], v236, s[48:51], s41 offen offset:16 sc1 nt
  s_cmp_lt_u32 s47, 0x40000
  s_cbranch_scc1 L_h_ml
L_h_ml_ok:
  s_mov_b64 exec, -1
  buffer_load_dwordx4 v[32:35], v235, s[48:51], s43 offen offset:0 sc1 nt
  buffer_load_dwordx4 v[36:39], v235, s[48:51], s43 offen offset:1024 sc1 nt
  v_max_f32 v18, v24, v28
  s_branch L_h_mlok
L_streamer:
  s_setprio 2
  s_mov_b32 s69, 0
  s_lshl_b32 s7, s3, 2
  v_mov_b32 v61, s7
  v_mov_b32 v6, 0
  ds_write_b32 v61, v6 offset:16912
  s_memrealtime s[64:65]
  v_mov_b32 v56, 0
  v_mov_b32 v7, 0
  ds_write_b64 v56, v[6:7] offset:16936
  s_cmp_eq_u32 s3, 1
  s_cselect_b32 s7, 0, 4632
  v_mov_b32 v57, s7
  s_waitcnt lgkmcnt(0)
  s_add_u32 s64, s64, 0x100000
  v_mov_b32 v7, s64
  ds_write_b32 v56, v7 offset:16944
  s_lshl_b32 s7, s3, 8
  v_lshl_add_u32 v62, v0, 2, s7
  s_lshl_b32 s7, s3, 12
  v_and_b32 v8, 60, v0
  v_add_u32 v8, s7, v8
  v_mov_b32 v5, 0xff800000
  s_mov_b32 s15, 0
  s_waitcnt vmcnt(4)
  buffer_load_dwordx4 v[84:87], v48, s[8:11], s12 offen nt
  s_waitcnt vmcnt(4)
  buffer_load_dwordx4 v[88:91], v49, s[8:11], s12 offen nt
  s_waitcnt vmcnt(4)
  buffer_load_dwordx4 v[92:95], v50, s[8:11], s12 offen nt
  s_waitcnt vmcnt(4)
  s_xor_b32 s12, s59, 0x40800
  buffer_load_dwordx4 v[96:99], v3, s[8:11], s12 offen nt
  s_waitcnt vmcnt(4)
  buffer_load_dwordx4 v[100:103], v48, s[8:11], s12 offen nt
  s_waitcnt vmcnt(4)
  buffer_load_dwordx4 v[104:107], v49, s[8:11], s12 offen nt
  s_waitcnt vmcnt(4)
  buffer_load_dwordx4 v[108:111], v50, s[8:11], s12 offen nt
  s_waitcnt vmcnt(4)
  s_xor_b32 s12, s59, 0x60c00
  buffer_load_dwordx4 v[112:115], v3, s[8:11], s12 offen nt
  s_waitcnt vmcnt(4)
  buffer_load_dwordx4 v[116:119], v48, s[8:11], s12 offen nt
  s_waitcnt vmcnt(4)
  buffer_load_dwordx4 v[120:123], v49, s[8:11], s12 offen nt
  s_waitcnt vmcnt(4)
  buffer_load_dwordx4 v[124:127], v50, s[8:11], s12 offen nt
  s_waitcnt vmcnt(4)
  s_and_b32 s59, s13, 7
  s_mul_i32 s59, s59, 0x4800
  s_and_b32 s59, s59, 0x7000
  s_and_b32 s12, s13, 1
  s_lshl_b32 s12, s12, 10
  s_or_b32 s59, s59, s12
  s_lshl_b32 s12, s13, 19
  s_or_b32 s59, s59, s12
  s_xor_b32 s59, s59, s14
  s_add_u32 s13, s13, 1
  s_and_b32 s13, s13, 15
  buffer_load_dwordx4 v[128:131], v3, s[8:11], s59 offen nt
  s_waitcnt vmcnt(4)
  buffer_load_dwordx4 v[132:135], v48, s[8:11], s59 offen nt
  s_waitcnt vmcnt(4)
  buffer_load_dwordx4 v[136:139], v49, s[8:11], s59 offen nt
  s_waitcnt vmcnt(4)
  buffer_load_dwordx4 v[140:143], v50, s[8:11], s59 offen nt
  s_waitcnt vmcnt(4)
  s_xor_b32 s12, s59, 0x20400
  buffer_load_dwordx4 v[144:147], v3, s[8:11], s12 offen nt
  s_waitcnt vmcnt(4)
  buffer_load_dwordx4 v[148:151], v48, s[8:11], s12 offen nt
  s_waitcnt vmcnt(4)
  buffer_load_dwordx4 v[152:155], v49, s[8:11], s12 offen nt
  s_waitcnt vmcnt(4)
  buffer_load_dwordx4 v[156:159], v50, s[8:11], s12 offen nt
  s_waitcnt vmcnt(4)
  s_xor_b32 s12, s59, 0x40800
  buffer_load_dwordx4 v[160:163], v3, s[8:11], s12 offen nt
  s_waitcnt vmcnt(4)
  buffer_load_dwordx4 v[164:167], v48, s[8:11], s12 offen nt
  s_waitcnt vmcnt(4)
  buffer_load_dwordx4 v[168:171], v49, s[8:11], s12 offen nt
  s_waitcnt vmcnt(4)
  buffer_load_dwordx4 v[172:175], v50, s[8:11], s12 offen nt
  s_waitcnt vmcnt(4)
  s_xor_b32 s12, s59, 0x60c00
  buffer_load_dwordx4 v[176:179], v3, s[8:11], s12 offen nt
  s_branch L_post
L_ffn:
  v_lshrrev_b32 v6, 1, v1
  v_and_b32 v7, 1, v1
  v_lshl_add_u32 v6, v7, 1, v6
  v_lshl_add_u32 v6, v2, 2, v6
  v_lshlrev_b32 v231, 4, v6
  s_mul_i32 s56, s5, 20480
  s_mul_i32 s47, s4, 640
  s_add_u32 s56, s56, s47
  s_add_u32 s56, s56, 524288
  s_cmp_lt_u32 s4, 27
  s_cbranch_scc1 L_f_go
  s_barrier
  v_mov_b32 v6, 0
  ds_read_b64 v[6:7], v6 offset:16928
  s_waitcnt lgkmcnt(0)
  v_readfirstlane_b32 s54, v6
  v_readfirstlane_b32 s57, v7
  v_mov_b32 v28, 0
  v_mov_b32 v29, 0
  v_mov_b32 v30, 0
  v_mov_b32 v31, 0
  s_branch L_f_pub
L_f_go:
  buffer_load_dword v16, v3, s[8:11], 0 offen offset:0
  buffer_load_dword v17, v3, s[8:11], 0 offen offset:256
  buffer_load_dword v18, v3, s[8:11], 0 offen offset:512
  buffer_load_dword v19, v3, s[8:11], 0 offen offset:768
  buffer_load_dword v20, v3, s[8:11], 0 offen offset:1024
  buffer_load_ushort v21, v4, s[8:11], s7 offen offset:0
  buffer_load_ushort v22, v4, s[8:11], s7 offen offset:128
  s_mov_b32 s44, 0xff00ff00
  s_mov_b32 s45, 0xff00ff00
  v_mov_b32 v38, s28
  v_mov_b32 v39, s29
  v_mov_b32 v8, s30
  v_mov_b32 v9, s31
  v_cndmask_b32 v38, v38, v8, s[44:45]
  v_cndmask_b32 v39, v39, v9, s[44:45]
  v_and_b32 v8, 7, v0
  v_lshlrev_b32 v8, 4, v8
  v_mul_u32_u24 v9, 3456, v1
  v_add_u32 v8, v8, v9
  s_mul_i32 s47, s5, 276480
  s_lshl_b32 s41, s4, 7
  s_add_u32 s47, s47, s41
  v_add_u32 v8, s47, v8
  v_mov_b32 v9, 0
  v_lshl_add_u64 v[38:39], v[38:39], 0, v[8:9]
  s_mov_b32 s42, 13824
  s_mov_b32 s43, 0
  global_load_dwordx4 v[64:67], v[38:39], off nt
  v_lshl_add_u64 v[38:39], v[38:39], 0, s[42:43]
  global_load_dwordx4 v[68:71], v[38:39], off nt
  v_lshl_add_u64 v[38:39], v[38:39], 0, s[42:43]
  global_load_dwordx4 v[72:75], v[38:39], off nt
  v_lshl_add_u64 v[38:39], v[38:39], 0, s[42:43]
  global_load_dwordx4 v[76:79], v[38:39], off nt
  v_lshl_add_u64 v[38:39], v[38:39], 0, s[42:43]
  global_load_dwordx4 v[80:83], v[38:39], off nt
  v_lshl_add_u64 v[38:39], v[38:39], 0, s[42:43]
  global_load_dwordx4 v[84:87], v[38:39], off nt
  v_lshl_add_u64 v[38:39], v[38:39], 0, s[42:43]
  global_load_dwordx4 v[88:91], v[38:39], off nt
  v_lshl_add_u64 v[38:39], v[38:39], 0, s[42:43]
  global_load_dwordx4 v[92:95], v[38:39], off nt
  v_lshl_add_u64 v[38:39], v[38:39], 0, s[42:43]
  global_load_dwordx4 v[96:99], v[38:39], off nt
  v_lshl_add_u64 v[38:39], v[38:39], 0, s[42:43]
  global_load_dwordx4 v[100:103], v[38:39], off nt
  v_lshl_add_u64 v[38:39], v[38:39], 0, s[42:43]
  global_load_dwordx4 v[104:107], v[38:39], off nt
  v_lshl_add_u64 v[38:39], v[38:39], 0, s[42:43]
  global_load_dwordx4 v[108:111], v[38:39], off nt
  v_lshl_add_u64 v[38:39], v[38:39], 0, s[42:43]
  global_load_dwordx4 v[112:115], v[38:39], off nt
  v_lshl_add_u64 v[38:39], v[38:39], 0, s[42:43]
  global_load_dwordx4 v[116:119], v[38:39], off nt
  v_lshl_add_u64 v[38:39], v[38:39], 0, s[42:43]
  global_load_dwordx4 v[120:123], v[38:39], off nt
  v_lshl_add_u64 v[38:39], v[38:39], 0, s[42:43]
  global_load_dwordx4 v[124:127], v[38:39], off nt
  v_lshl_add_u64 v[38:39], v[38:39], 0, s[42:43]
  global_load_dwordx4 v[128:131], v[38:39], off nt
  v_lshl_add_u64 v[38:39], v[38:39], 0, s[42:43]
  global_load_dwordx4 v[132:135], v[38:39], off nt
  v_lshl_add_u64 v[38:39], v[38:39], 0, s[42:43]
  global_load_dwordx4 v[136:139], v[38:39], off nt
  v_lshl_add_u64 v[38:39], v[38:39], 0, s[42:43]
  global_load_dwordx4 v[140:143], v[38:39], off nt
  v_lshl_add_u64 v[38:39], v[38:39], 0, s[42:43]
  s_mov_b32 s12, s32
  s_mov_b32 s13, s33
  s_mov_b32 s14, 2211840
  s_mov_b32 s15, 0x20000
  v_mul_u32_u24 v36, 1280, v1
  v_lshl_add_u32 v36, v2, 4, v36
  v_mov_b32 v37, 0x7fffffff
  s_mov_b32 s44, 0x03ff03ff
  s_mov_b32 s45, 0x03ff03ff
  v_cndmask_b32 v36, v37, v36, s[44:45]
  s_mul_i32 s46, s4, 81920
  s_add_u32 s46, s46, s7
  buffer_load_dwordx4 v[144:147], v36, s[12:15], s46 offen nt
  s_add_u32 s46, s46, 5120
  buffer_load_dwordx4 v[148:151], v36, s[12:15], s46 offen nt
  s_add_u32 s46, s46, 5120
  buffer_load_dwordx4 v[152:155], v36, s[12:15], s46 offen nt
  s_add_u32 s46, s46, 5120
  buffer_load_dwordx4 v[156:159], v36, s[12:15], s46 offen nt
  s_add_u32 s46, s46, 5120
  buffer_load_dwordx4 v[160:163], v36, s[12:15], s46 offen nt
  s_add_u32 s46, s46, 5120
  buffer_load_dwordx4 v[164:167], v36, s[12:15], s46 offen nt
  s_add_u32 s46, s46, 5120
  buffer_load_dwordx4 v[168:171], v36, s[12:15], s46 offen nt
  s_add_u32 s46, s46, 5120
  buffer_load_dwordx4 v[172:175], v36, s[12:15], s46 offen nt
  s_add_u32 s46, s46, 5120
  buffer_load_dwordx4 v[176:179], v36, s[12:15], s46 offen nt
  s_add_u32 s46, s46, 5120
  buffer_load_dwordx4 v[180:183], v36, s[12:15], s46 offen nt
  s_add_u32 s46, s46, 5120
  buffer_load_dwordx4 v[184:187], v36, s[12:15], s46 offen nt
  s_add_u32 s46, s46, 5120
  buffer_load_dwordx4 v[188:191], v36, s[12:15], s46 offen nt
  s_add_u32 s46, s46, 5120
  buffer_load_dwordx4 v[192:195], v36, s[12:15], s46 offen nt
  s_add_u32 s46, s46, 5120
  buffer_load_dwordx4 v[196:199], v36, s[12:15], s46 offen nt
  s_add_u32 s46, s46, 5120
  buffer_load_dwordx4 v[200:203], v36, s[12:15], s46 offen nt
  s_add_u32 s46, s46, 5120
  buffer_load_dwordx4 v[204:207], v36, s[12:15], s46 offen nt
  s_add_u32 s46, s46, 5120
  s_barrier
  v_mov_b32 v6, 0
  ds_read_b64 v[6:7], v6 offset:16928
  s_waitcnt lgkmcnt(0)
  v_readfirstlane_b32 s54, v6
  v_readfirstlane_b32 s57, v7
  v_and_b32 v6, 1, v0
  v_lshlrev_b32 v6, 4, v6
  v_mov_b32 v12, 0xffff
  v_lshlrev_b32 v6, v6, v12
  s_mov_b32 s44, 0x3030303
  s_mov_b32 s45, 0x3030303
  v_cndmask_b32 v12, 0, v6, s[44:45]
  s_mov_b32 s44, 0xc0c0c0c
  s_mov_b32 s45, 0xc0c0c0c
  v_cndmask_b32 v13, 0, v6, s[44:45]
  s_mov_b32 s44, 0x30303030
  s_mov_b32 s45, 0x30303030
  v_cndmask_b32 v14, 0, v6, s[44:45]
  s_mov_b32 s44, 0xc0c0c0c0
  s_mov_b32 s45, 0xc0c0c0c0
  v_cndmask_b32 v15, 0, v6, s[44:45]
  s_waitcnt vmcnt(36)
  v_lshlrev_b32 v24, 16, v16
  v_and_b32 v25, 0xffff0000, v16
  v_lshlrev_b32 v26, 16, v17
  v_and_b32 v27, 0xffff0000, v17
  v_lshlrev_b32 v28, 16, v18
  v_and_b32 v29, 0xffff0000, v18
  v_lshlrev_b32 v30, 16, v19
  v_and_b32 v31, 0xffff0000, v19
  v_lshlrev_b32 v32, 16, v20
  v_and_b32 v33, 0xffff0000, v20
  v_add_f32 v34, v24, v25
  v_add_f32 v34, v34, v26
  v_add_f32 v34, v34, v27
  v_add_f32 v34, v34, v28
  v_add_f32 v34, v34, v29
  v_add_f32 v34, v34, v30
  v_add_f32 v34, v34, v31
  v_add_f32 v34, v34, v32
  v_add_f32 v34, v34, v33
  s_nop 1
  v_add_f32_dpp v34, v34, v34 row_ror:1 row_mask:0xf bank_mask:0xf
  s_nop 1
  v_add_f32_dpp v34, v34, v34 row_ror:2 row_mask:0xf bank_mask:0xf
  s_nop 1
  v_add_f32_dpp v34, v34, v34 row_ror:4 row_mask:0xf bank_mask:0xf
  s_nop 1
  v_add_f32_dpp v34, v34, v34 row_ror:8 row_mask:0xf bank_mask:0xf
  v_mov_b32 v16, v34
  s_nop 1
  v_permlane16_swap_b32 v34, v16
  s_nop 0
  v_add_f32 v34, v34, v16
  v_mov_b32 v16, v34
  s_nop 1
  v_permlane32_swap_b32 v34, v16
  s_nop 0
  v_add_f32 v34, v34, v16
  v_mul_f32 v34, 0x3acccccd, v34
  v_sub_f32 v16, v24, v34
  v_mul_f32 v35, v16, v16
  v_sub_f32 v16, v25, v34
  v_fmac_f32 v35, v16, v16
  v_sub_f32 v16, v26, v34
  v_fmac_f32 v35, v16, v16
  v_sub_f32 v16, v27, v34
  v_fmac_f32 v35, v16, v16
  v_sub_f32 v16, v28, v34
  v_fmac_f32 v35, v16, v16
  v_sub_f32 v16, v29, v34
  v_fmac_f32 v35, v16, v16
  v_sub_f32 v16, v30, v34
  v_fmac_f32 v35, v16, v16
  v_sub_f32 v16, v31, v34
  v_fmac_f32 v35, v16, v16
  v_sub_f32 v16, v32, v34
  v_fmac_f32 v35, v16, v16
  v_sub_f32 v16, v33, v34
  v_fmac_f32 v35, v16, v16
  s_nop 1
  v_add_f32_dpp v35, v35, v35 row_ror:1 row_mask:0xf bank_mask:0xf
  s_nop 1
  v_add_f32_dpp v35, v35, v35 row_ror:2 row_mask:0xf bank_mask:0xf
  s_nop 1
  v_add_f32_dpp v35, v35, v35 row_ror:4 row_mask:0xf bank_mask:0xf
  s_nop 1
  v_add_f32_dpp v35, v35, v35 row_ror:8 row_mask:0xf bank_mask:0xf
  v_mov_b32 v16, v35
  s_nop 1
  v_permlane16_swap_b32 v35, v16
  s_nop 0
  v_add_f32 v35, v35, v16
  v_mov_b32 v16, v35
  s_nop 1
  v_permlane32_swap_b32 v35, v16
  s_nop 0
  v_add_f32 v35, v35, v16
  v_mul_f32 v35, 0x3acccccd, v35
  v_cvt_pk_bf16_f32 v34, v34, v34
  v_and_b32 v34, 0xffff0000, v34
  v_cvt_pk_bf16_f32 v35, v35, v35
  v_and_b32 v35, 0xffff0000, v35
  v_add_f32 v35, 0x3727c5ac, v35
  v_cvt_pk_bf16_f32 v35, v35, v35
  v_and_b32 v35, 0xffff0000, v35
  v_sqrt_f32 v35, v35
  s_nop 0
  v_cvt_pk_bf16_f32 v35, v35, v35
  v_and_b32 v35, 0xffff0000, v35
  v_rcp_f32 v35, v35
  s_nop 0
  v_lshlrev_b32 v21, 16, v21
  v_lshlrev_b32 v22, 16, v22
  v_sub_f32 v21, v21, v34
  v_cvt_pk_bf16_f32 v21, v21, v21
  v_and_b32 v21, 0xffff0000, v21
  v_mul_f32 v21, v21, v35
  v_cvt_pk_bf16_f32 v21, v21, v21
  v_sub_f32 v22, v22, v34
  v_cvt_pk_bf16_f32 v22, v22, v22
  v_and_b32 v22, 0xffff0000, v22
  v_mul_f32 v22, v22, v35
  v_cvt_pk_bf16_f32 v22, v22, v22
  s_nop 1
  v_and_b32_dpp v24, v21, v12 row_newbcast:0 row_mask:0xf bank_mask:0xf
  v_and_b32_dpp v25, v21, v13 row_newbcast:0 row_mask:0xf bank_mask:0xf
  v_and_b32_dpp v26, v21, v14 row_newbcast:0 row_mask:0xf bank_mask:0xf
  v_and_b32_dpp v27, v21, v15 row_newbcast:0 row_mask:0xf bank_mask:0xf
  s_waitcnt vmcnt(35)
  s_nop 0
  v_mfma_f32_16x16x32_bf16 v[28:31], v[24:27], v[64:67], 0
  v_and_b32_dpp v24, v21, v12 row_newbcast:1 row_mask:0xf bank_mask:0xf
  v_and_b32_dpp v25, v21, v13 row_newbcast:1 row_mask:0xf bank_mask:0xf
  v_and_b32_dpp v26, v21, v14 row_newbcast:1 row_mask:0xf bank_mask:0xf
  v_and_b32_dpp v27, v21, v15 row_newbcast:1 row_mask:0xf bank_mask:0xf
  s_waitcnt vmcnt(34)
  s_nop 0
  v_mfma_f32_16x16x32_bf16 v[28:31], v[24:27], v[68:71], v[28:31]
  v_and_b32_dpp v24, v21, v12 row_newbcast:2 row_mask:0xf bank_mask:0xf
  v_and_b32_dpp v25, v21, v13 row_newbcast:2 row_mask:0xf bank_mask:0xf
  v_and_b32_dpp v26, v21, v14 row_newbcast:2 row_mask:0xf bank_mask:0xf
  v_and_b32_dpp v27, v21, v15 row_newbcast:2 row_mask:0xf bank_mask:0xf
  s_waitcnt vmcnt(33)
  s_nop 0
  v_mfma_f32_16x16x32_bf16 v[28:31], v[24:27], v[72:75], v[28:31]
  v_and_b32_dpp v24, v21, v12 row_newbcast:3 row_mask:0xf bank_mask:0xf
  v_and_b32_dpp v25, v21, v13 row_newbcast:3 row_mask:0xf bank_mask:0xf
  v_and_b32_dpp v26, v21, v14 row_newbcast:3 row_mask:0xf bank_mask:0xf
  v_and_b32_dpp v27, v21, v15 row_newbcast:3 row_mask:0xf bank_mask:0xf
  s_waitcnt vmcnt(32)
  s_nop 0
  v_mfma_f32_16x16x32_bf16 v[28:31], v[24:27], v[76:79], v[28:31]
  v_and_b32_dpp v24, v21, v12 row_newbcast:4 row_mask:0xf bank_mask:0xf
  v_and_b32_dpp v25, v21, v13 row_newbcast:4 row_mask:0xf bank_mask:0xf
  v_and_b32_dpp v26, v21, v14 row_newbcast:4 row_mask:0xf bank_mask:0xf
  v_and_b32_dpp v27, v21, v15 row_newbcast:4 row_mask:0xf bank_mask:0xf
  s_waitcnt vmcnt(31)
  s_nop 0
  v_mfma_f32_16x16x32_bf16 v[28:31], v[24:27], v[80:83], v[28:31]
  v_and_b32_dpp v24, v21, v12 row_newbcast:5 row_mask:0xf bank_mask:0xf
  v_and_b32_dpp v25, v21, v13 row_newbcast:5 row_mask:0xf bank_mask:0xf
  v_and_b32_dpp v26, v21, v14 row_newbcast:5 row_mask:0xf bank_mask:0xf
  v_and_b32_dpp v27, v21, v15 row_newbcast:5 row_mask:0xf bank_mask:0xf
  s_waitcnt vmcnt(30)
  s_nop 0
  v_mfma_f32_16x16x32_bf16 v[28:31], v[24:27], v[84:87], v[28:31]
  v_and_b32_dpp v24, v21, v12 row_newbcast:6 row_mask:0xf bank_mask:0xf
  v_and_b32_dpp v25, v21, v13 row_newbcast:6 row_mask:0xf bank_mask:0xf
  v_and_b32_dpp v26, v21, v14 row_newbcast:6 row_mask:0xf bank_mask:0xf
  v_and_b32_dpp v27, v21, v15 row_newbcast:6 row_mask:0xf bank_mask:0xf
  s_waitcnt vmcnt(29)
  s_nop 0
  v_mfma_f32_16x16x32_bf16 v[28:31], v[24:27], v[88:91], v[28:31]
  v_and_b32_dpp v24, v21, v12 row_newbcast:7 row_mask:0xf bank_mask:0xf
  v_and_b32_dpp v25, v21, v13 row_newbcast:7 row_mask:0xf bank_mask:0xf
  v_and_b32_dpp v26, v21, v14 row_newbcast:7 row_mask:0xf bank_mask:0xf
  v_and_b32_dpp v27, v21, v15 row_newbcast:7 row_mask:0xf bank_mask:0xf
  s_waitcnt vmcnt(28)
  s_nop 0
  v_mfma_f32_16x16x32_bf16 v[28:31], v[24:27], v[92:95], v[28:31]
  v_and_b32_dpp v24, v21, v12 row_newbcast:8 row_mask:0xf bank_mask:0xf
  v_and_b32_dpp v25, v21, v13 row_newbcast:8 row_mask:0xf bank_mask:0xf
  v_and_b32_dpp v26, v21, v14 row_newbcast:8 row_mask:0xf bank_mask:0xf
  v_and_b32_dpp v27, v21, v15 row_newbcast:8 row_mask:0xf bank_mask:0xf
  s_waitcnt vmcnt(27)
  s_nop 0
  v_mfma_f32_16x16x32_bf16 v[28:31], v[24:27], v[96:99], v[28:31]
  v_and_b32_dpp v24, v21, v12 row_newbcast:9 row_mask:0xf bank_mask:0xf
  v_and_b32_dpp v25, v21, v13 row_newbcast:9 row_mask:0xf bank_mask:0xf
  v_and_b32_dpp v26, v21, v14 row_newbcast:9 row_mask:0xf bank_mask:0xf
  v_and_b32_dpp v27, v21, v15 row_newbcast:9 row_mask:0xf bank_mask:0xf
  s_waitcnt vmcnt(26)
  s_nop 0
  v_mfma_f32_16x16x32_bf16 v[28:31], v[24:27], v[100:103], v[28:31]
  v_and_b32_dpp v24, v21, v12 row_newbcast:10 row_mask:0xf bank_mask:0xf
  v_and_b32_dpp v25, v21, v13 row_newbcast:10 row_mask:0xf bank_mask:0xf
  v_and_b32_dpp v26, v21, v14 row_newbcast:10 row_mask:0xf bank_mask:0xf
  v_and_b32_dpp v27, v21, v15 row_newbcast:10 row_mask:0xf bank_mask:0xf
  s_waitcnt vmcnt(25)
  s_nop 0
  v_mfma_f32_16x16x32_bf16 v[28:31], v[24:27], v[104:107], v[28:31]
  v_and_b32_dpp v24, v21, v12 row_newbcast:11 row_mask:0xf bank_mask:0xf
  v_and_b32_dpp v25, v21, v13 row_newbcast:11 row_mask:0xf bank_mask:0xf
  v_and_b32_dpp v26, v21, v14 row_newbcast:11 row_mask:0xf bank_mask:0xf
  v_and_b32_dpp v27, v21, v15 row_newbcast:11 row_mask:0xf bank_mask:0xf
  s_waitcnt vmcnt(24)
  s_nop 0
  v_mfma_f32_16x16x32_bf16 v[28:31], v[24:27], v[108:111], v[28:31]
  v_and_b32_dpp v24, v21, v12 row_newbcast:12 row_mask:0xf bank_mask:0xf
  v_and_b32_dpp v25, v21, v13 row_newbcast:12 row_mask:0xf bank_mask:0xf
  v_and_b32_dpp v26, v21, v14 row_newbcast:12 row_mask:0xf bank_mask:0xf
  v_and_b32_dpp v27, v21, v15 row_newbcast:12 row_mask:0xf bank_mask:0xf
  s_waitcnt vmcnt(23)
  s_nop 0
  v_mfma_f32_16x16x32_bf16 v[28:31], v[24:27], v[112:115], v[28:31]
  v_and_b32_dpp v24, v21, v12 row_newbcast:13 row_mask:0xf bank_mask:0xf
  v_and_b32_dpp v25, v21, v13 row_newbcast:13 row_mask:0xf bank_mask:0xf
  v_and_b32_dpp v26, v21, v14 row_newbcast:13 row_mask:0xf bank_mask:0xf
  v_and_b32_dpp v27, v21, v15 row_newbcast:13 row_mask:0xf bank_mask:0xf
  s_waitcnt vmcnt(22)
  s_nop 0
  v_mfma_f32_16x16x32_bf16 v[28:31], v[24:27], v[116:119], v[28:31]
  v_and_b32_dpp v24, v21, v12 row_newbcast:14 row_mask:0xf bank_mask:0xf
  v_and_b32_dpp v25, v21, v13 row_newbcast:14 row_mask:0xf bank_mask:0xf
  v_and_b32_dpp v26, v21, v14 row_newbcast:14 row_mask:0xf bank_mask:0xf
  v_and_b32_dpp v27, v21, v15 row_newbcast:14 row_mask:0xf bank_mask:0xf
  s_waitcnt vmcnt(21)
  s_nop 0
  v_mfma_f32_16x16x32_bf16 v[28:31], v[24:27], v[120:123], v[28:31]
  v_and_b32_dpp v24, v21, v12 row_newbcast:15 row_mask:0xf bank_mask:0xf
  v_and_b32_dpp v25, v21, v13 row_newbcast:15 row_mask:0xf bank_mask:0xf
  v_and_b32_dpp v26, v21, v14 row_newbcast:15 row_mask:0xf bank_mask:0xf
  v_and_b32_dpp v27, v21, v15 row_newbcast:15 row_mask:0xf bank_mask:0xf
  s_waitcnt vmcnt(20)
  s_nop 0
  v_mfma_f32_16x16x32_bf16 v[28:31], v[24:27], v[124:127], v[28:31]
  v_and_b32_dpp v24, v22, v12 row_newbcast:0 row_mask:0xf bank_mask:0xf
  v_and_b32_dpp v25, v22, v13 row_newbcast:0 row_mask:0xf bank_mask:0xf
  v_and_b32_dpp v26, v22, v14 row_newbcast:0 row_mask:0xf bank_mask:0xf
  v_and_b32_dpp v27, v22, v15 row_newbcast:0 row_mask:0xf bank_mask:0xf
  s_waitcnt vmcnt(19)
  s_nop 0
  v_mfma_f32_16x16x32_bf16 v[28:31], v[24:27], v[128:131], v[28:31]
  v_and_b32_dpp v24, v22, v12 row_newbcast:1 row_mask:0xf bank_mask:0xf
  v_and_b32_dpp v25, v22, v13 row_newbcast:1 row_mask:0xf bank_mask:0xf
  v_and_b32_dpp v26, v22, v14 row_newbcast:1 row_mask:0xf bank_mask:0xf
  v_and_b32_dpp v27, v22, v15 row_newbcast:1 row_mask:0xf bank_mask:0xf
  s_waitcnt vmcnt(18)
  s_nop 0
  v_mfma_f32_16x16x32_bf16 v[28:31], v[24:27], v[132:135], v[28:31]
  v_and_b32_dpp v24, v22, v12 row_newbcast:2 row_mask:0xf bank_mask:0xf
  v_and_b32_dpp v25, v22, v13 row_newbcast:2 row_mask:0xf bank_mask:0xf
  v_and_b32_dpp v26, v22, v14 row_newbcast:2 row_mask:0xf bank_mask:0xf
  v_and_b32_dpp v27, v22, v15 row_newbcast:2 row_mask:0xf bank_mask:0xf
  s_waitcnt vmcnt(17)
  s_nop 0
  v_mfma_f32_16x16x32_bf16 v[28:31], v[24:27], v[136:139], v[28:31]
  v_and_b32_dpp v24, v22, v12 row_newbcast:3 row_mask:0xf bank_mask:0xf
  v_and_b32_dpp v25, v22, v13 row_newbcast:3 row_mask:0xf bank_mask:0xf
  v_and_b32_dpp v26, v22, v14 row_newbcast:3 row_mask:0xf bank_mask:0xf
  v_and_b32_dpp v27, v22, v15 row_newbcast:3 row_mask:0xf bank_mask:0xf
  s_waitcnt vmcnt(16)
  s_nop 0
  v_mfma_f32_16x16x32_bf16 v[28:31], v[24:27], v[140:143], v[28:31]
  s_lshl_b32 s42, s6, 10
  s_add_u32 s42, s42, 2621440
  s_and_b32 s41, s42, 0xffffe000
  s_nop 1
  s_mov_b32 s44, 0
  s_mov_b32 s45, -1
  v_mov_b32 v25, s54
  v_mov_b32 v27, s54
  v_cndmask_b32 v24, v28, v30, s[44:45]
  v_cndmask_b32 v26, v29, v31, s[44:45]
  s_cmp_eq_u32 s57, 0
  s_cbranch_scc0 L_fx_far
  buffer_store_dwordx4 v[24:27], v231, s[48:51], s42 offen
  s_branch L_fx_fin
L_fx_far:
  buffer_store_dwordx4 v[24:27], v231, s[48:51], s42 offen sc1
L_fx_fin:
  s_waitcnt vmcnt(0)
  s_sleep 16
  s_mov_b32 s47, 0
L_f_x:
  s_add_u32 s43, s41, 4096
  buffer_load_dwordx4 v[64:67], v228, s[48:51], s41 offen offset:0 sc1 nt
  buffer_load_dwordx4 v[68:71], v228, s[48:51], s41 offen offset:1024 sc1 nt
  buffer_load_dwordx4 v[72:75], v228, s[48:51], s41 offen offset:2048 sc1 nt
  buffer_load_dwordx4 v[76:79], v228, s[48:51], s41 offen offset:3072 sc1 nt
  buffer_load_dwordx4 v[80:83], v228, s[48:51], s43 offen offset:0 sc1 nt
  buffer_load_dwordx4 v[84:87], v228, s[48:51], s43 offen offset:1024 sc1 nt
  buffer_load_dwordx4 v[88:91], v228, s[48:51], s43 offen offset:2048 sc1 nt
  buffer_load_dwordx4 v[92:95], v228, s[48:51], s43 offen offset:3072 sc1 nt
  s_waitcnt vmcnt(7)
  v_and_b32 v6, v65, v67
  v_or_b32 v7, v65, v67
  s_waitcnt vmcnt(6)
  v_bitop3_b32 v6, v6, v69, v71 bitop3:0x80
  v_or3_b32 v7, v7, v69, v71
  v_add_f32 v64, v64, v68
  v_add_f32 v66, v66, v70
  s_waitcnt vmcnt(5)
  v_bitop3_b32 v6, v6, v73, v75 bitop3:0x80
  v_or3_b32 v7, v7, v73, v75
  v_add_f32 v64, v64, v72
  v_add_f32 v66, v66, v74
  s_waitcnt vmcnt(4)
  v_bitop3_b32 v6, v6, v77, v79 bitop3:0x80
  v_or3_b32 v7, v7, v77, v79
  v_add_f32 v64, v64, v76
  v_add_f32 v66, v66, v78
  s_waitcnt vmcnt(3)
  v_bitop3_b32 v6, v6, v81, v83 bitop3:0x80
  v_or3_b32 v7, v7, v81, v83
  v_add_f32 v64, v64, v80
  v_add_f32 v66, v66, v82
  s_waitcnt vmcnt(2)
  v_bitop3_b32 v6, v6, v85, v87 bitop3:0x80
  v_or3_b32 v7, v7, v85, v87
  v_add_f32 v64, v64, v84
  v_add_f32 v66, v66, v86
  s_waitcnt vmcnt(1)
  v_bitop3_b32 v6, v6, v89, v91 bitop3:0x80
  v_or3_b32 v7, v7, v89, v91
  v_add_f32 v64, v64, v88
  v_add_f32 v66, v66, v90
  s_waitcnt vmcnt(0)
  v_bitop3_b32 v6, v6, v93, v95 bitop3:0x80
  v_or3_b32 v7, v7, v93, v95
  v_add_f32 v64, v64, v92
  v_add_f32 v66, v66, v94
  v_xor_b32 v8, s54, v6
  v_xor_b32 v9, s54, v7
  v_cmp_lt_u32 vcc, 0, v8
  v_cmp_lt_u32 s[44:45], 0, v9
  s_add_u32 s47, s47, 1
  s_or_b64 vcc, vcc, s[44:45]
  s_cbranch_scc0 L_f_x_ok
  s_sleep 16
  s_cmp_lt_u32 s47, 0x40000
  s_cbranch_scc1 L_f_x
L_f_x_ok:
  v_cvt_pk_bf16_f32 v64, v64, v64
  v_and_b32 v64, 0xffff0000, v64
  v_cvt_pk_bf16_f32 v66, v66, v66
  v_and_b32 v66, 0xffff0000, v66
  v_mov_b32 v65, v64
  v_mov_b32 v67, v66
  s_nop 1
  v_permlane32_swap_b32 v64, v65
  v_permlane32_swap_b32 v66, v67
  s_nop 0
  v_max_f32 v64, 0, v64
  v_max_f32 v66, 0, v66
  v_mul_f32 v64, v64, v65
  v_mul_f32 v66, v66, v67
  v_cvt_pk_bf16_f32 v64, v64, v64
  v_cvt_pk_bf16_f32 v65, v66, v66
  v_lshlrev_b32 v6, 3, v0
  v_and_b32 v6, 0xff, v6
  ds_write_b64 v6, v[64:65] offset:21312
  v_lshlrev_b32 v6, 1, v4
  ds_read_b32 v21, v6 offset:21312
  s_waitcnt lgkmcnt(0)
  v_and_b32_dpp v24, v21, v12 row_newbcast:0 row_mask:0xf bank_mask:0xf
  v_and_b32_dpp v25, v21, v13 row_newbcast:0 row_mask:0xf bank_mask:0xf
  v_and_b32_dpp v26, v21, v14 row_newbcast:0 row_mask:0xf bank_mask:0xf
  v_and_b32_dpp v27, v21, v15 row_newbcast:0 row_mask:0xf bank_mask:0xf
  s_nop 1
  v_mfma_f32_16x16x32_bf16 v[28:31], v[24:27], v[144:147], 0
  v_and_b32_dpp v24, v21, v12 row_newbcast:1 row_mask:0xf bank_mask:0xf
  v_and_b32_dpp v25, v21, v13 row_newbcast:1 row_mask:0xf bank_mask:0xf
  v_and_b32_dpp v26, v21, v14 row_newbcast:1 row_mask:0xf bank_mask:0xf
  v_and_b32_dpp v27, v21, v15 row_newbcast:1 row_mask:0xf bank_mask:0xf
  s_nop 1
  v_mfma_f32_16x16x32_bf16 v[28:31], v[24:27], v[148:151], v[28:31]
  v_and_b32_dpp v24, v21, v12 row_newbcast:2 row_mask:0xf bank_mask:0xf
  v_and_b32_dpp v25, v21, v13 row_newbcast:2 row_mask:0xf bank_mask:0xf
  v_and_b32_dpp v26, v21, v14 row_newbcast:2 row_mask:0xf bank_mask:0xf
  v_and_b32_dpp v27, v21, v15 row_newbcast:2 row_mask:0xf bank_mask:0xf
  s_nop 1
  v_mfma_f32_16x16x32_bf16 v[28:31], v[24:27], v[152:155], v[28:31]
  v_and_b32_dpp v24, v21, v12 row_newbcast:3 row_mask:0xf bank_mask:0xf
  v_and_b32_dpp v25, v21, v13 row_newbcast:3 row_mask:0xf bank_mask:0xf
  v_and_b32_dpp v26, v21, v14 row_newbcast:3 row_mask:0xf bank_mask:0xf
  v_and_b32_dpp v27, v21, v15 row_newbcast:3 row_mask:0xf bank_mask:0xf
  s_nop 1
  v_mfma_f32_16x16x32_bf16 v[28:31], v[24:27], v[156:159], v[28:31]
  v_and_b32_dpp v24, v21, v12 row_newbcast:4 row_mask:0xf bank_mask:0xf
  v_and_b32_dpp v25, v21, v13 row_newbcast:4 row_mask:0xf bank_mask:0xf
  v_and_b32_dpp v26, v21, v14 row_newbcast:4 row_mask:0xf bank_mask:0xf
  v_and_b32_dpp v27, v21, v15 row_newbcast:4 row_mask:0xf bank_mask:0xf
  s_nop 1
  v_mfma_f32_16x16x32_bf16 v[28:31], v[24:27], v[160:163], v[28:31]
  v_and_b32_dpp v24, v21, v12 row_newbcast:5 row_mask:0xf bank_mask:0xf
  v_and_b32_dpp v25, v21, v13 row_newbcast:5 row_mask:0xf bank_mask:0xf
  v_and_b32_dpp v26, v21, v14 row_newbcast:5 row_mask:0xf bank_mask:0xf
  v_and_b32_dpp v27, v21, v15 row_newbcast:5 row_mask:0xf bank_mask:0xf
  s_nop 1
  v_mfma_f32_16x16x32_bf16 v[28:31], v[24:27], v[164:167], v[28:31]
  v_and_b32_dpp v24, v21, v12 row_newbcast:6 row_mask:0xf bank_mask:0xf
  v_and_b32_dpp v25, v21, v13 row_newbcast:6 row_mask:0xf bank_mask:0xf
  v_and_b32_dpp v26, v21, v14 row_newbcast:6 row_mask:0xf bank_mask:0xf
  v_and_b32_dpp v27, v21, v15 row_newbcast:6 row_mask:0xf bank_mask:0xf
  s_nop 1
  v_mfma_f32_16x16x32_bf16 v[28:31], v[24:27], v[168:171], v[28:31]
  v_and_b32_dpp v24, v21, v12 row_newbcast:7 row_mask:0xf bank_mask:0xf
  v_and_b32_dpp v25, v21, v13 row_newbcast:7 row_mask:0xf bank_mask:0xf
  v_and_b32_dpp v26, v21, v14 row_newbcast:7 row_mask:0xf bank_mask:0xf
  v_and_b32_dpp v27, v21, v15 row_newbcast:7 row_mask:0xf bank_mask:0xf
  s_nop 1
  v_mfma_f32_16x16x32_bf16 v[28:31], v[24:27], v[172:175], v[28:31]
  v_and_b32_dpp v24, v21, v12 row_newbcast:8 row_mask:0xf bank_mask:0xf
  v_and_b32_dpp v25, v21, v13 row_newbcast:8 row_mask:0xf bank_mask:0xf
  v_and_b32_dpp v26, v21, v14 row_newbcast:8 row_mask:0xf bank_mask:0xf
  v_and_b32_dpp v27, v21, v15 row_newbcast:8 row_mask:0xf bank_mask:0xf
  s_nop 1
  v_mfma_f32_16x16x32_bf16 v[28:31], v[24:27], v[176:179], v[28:31]
  v_and_b32_dpp v24, v21, v12 row_newbcast:9 row_mask:0xf bank_mask:0xf
  v_and_b32_dpp v25, v21, v13 row_newbcast:9 row_mask:0xf bank_mask:0xf
  v_and_b32_dpp v26, v21, v14 row_newbcast:9 row_mask:0xf bank_mask:0xf
  v_and_b32_dpp v27, v21, v15 row_newbcast:9 row_mask:0xf bank_mask:0xf
  s_nop 1
  v_mfma_f32_16x16x32_bf16 v[28:31], v[24:27], v[180:183], v[28:31]
  v_and_b32_dpp v24, v21, v12 row_newbcast:10 row_mask:0xf bank_mask:0xf
  v_and_b32_dpp v25, v21, v13 row_newbcast:10 row_mask:0xf bank_mask:0xf
  v_and_b32_dpp v26, v21, v14 row_newbcast:10 row_mask:0xf bank_mask:0xf
  v_and_b32_dpp v27, v21, v15 row_newbcast:10 row_mask:0xf bank_mask:0xf
  s_nop 1
  v_mfma_f32_16x16x32_bf16 v[28:31], v[24:27], v[184:187], v[28:31]
  v_and_b32_dpp v24, v21, v12 row_newbcast:11 row_mask:0xf bank_mask:0xf
  v_and_b32_dpp v25, v21, v13 row_newbcast:11 row_mask:0xf bank_mask:0xf
  v_and_b32_dpp v26, v21, v14 row_newbcast:11 row_mask:0xf bank_mask:0xf
  v_and_b32_dpp v27, v21, v15 row_newbcast:11 row_mask:0xf bank_mask:0xf
  s_nop 1
  v_mfma_f32_16x16x32_bf16 v[28:31], v[24:27], v[188:191], v[28:31]
  v_and_b32_dpp v24, v21, v12 row_newbcast:12 row_mask:0xf bank_mask:0xf
  v_and_b32_dpp v25, v21, v13 row_newbcast:12 row_mask:0xf bank_mask:0xf
  v_and_b32_dpp v26, v21, v14 row_newbcast:12 row_mask:0xf bank_mask:0xf
  v_and_b32_dpp v27, v21, v15 row_newbcast:12 row_mask:0xf bank_mask:0xf
  s_nop 1
  v_mfma_f32_16x16x32_bf16 v[28:31], v[24:27], v[192:195], v[28:31]
  v_and_b32_dpp v24, v21, v12 row_newbcast:13 row_mask:0xf bank_mask:0xf
  v_and_b32_dpp v25, v21, v13 row_newbcast:13 row_mask:0xf bank_mask:0xf
  v_and_b32_dpp v26, v21, v14 row_newbcast:13 row_mask:0xf bank_mask:0xf
  v_and_b32_dpp v27, v21, v15 row_newbcast:13 row_mask:0xf bank_mask:0xf
  s_nop 1
  v_mfma_f32_16x16x32_bf16 v[28:31], v[24:27], v[196:199], v[28:31]
  v_and_b32_dpp v24, v21, v12 row_newbcast:14 row_mask:0xf bank_mask:0xf
  v_and_b32_dpp v25, v21, v13 row_newbcast:14 row_mask:0xf bank_mask:0xf
  v_and_b32_dpp v26, v21, v14 row_newbcast:14 row_mask:0xf bank_mask:0xf
  v_and_b32_dpp v27, v21, v15 row_newbcast:14 row_mask:0xf bank_mask:0xf
  s_nop 1
  v_mfma_f32_16x16x32_bf16 v[28:31], v[24:27], v[200:203], v[28:31]
  v_and_b32_dpp v24, v21, v12 row_newbcast:15 row_mask:0xf bank_mask:0xf
  v_and_b32_dpp v25, v21, v13 row_newbcast:15 row_mask:0xf bank_mask:0xf
  v_and_b32_dpp v26, v21, v14 row_newbcast:15 row_mask:0xf bank_mask:0xf
  v_and_b32_dpp v27, v21, v15 row_newbcast:15 row_mask:0xf bank_mask:0xf
  s_nop 1
  v_mfma_f32_16x16x32_bf16 v[28:31], v[24:27], v[204:207], v[28:31]
  s_nop 3
L_f_pub:
  s_mov_b32 s44, 0
  s_mov_b32 s45, -1
  v_mov_b32 v25, s54
  v_mov_b32 v27, s54
  v_cndmask_b32 v24, v28, v30, s[44:45]
  v_cndmask_b32 v26, v29, v31, s[44:45]
  s_mov_b32 exec_lo, 0x03ff03ff
  s_mov_b32 exec_hi, 0x03ff03ff
  buffer_store_dwordx4 v[24:27], v231, s[48:51], s56 offen sc1
  s_mov_b64 exec, -1
  s_branch L_h_shadow
L_pacer:
  v_mov_b32 v4, 0
  s_mov_b32 s52, 3
  s_mov_b32 s53, 1015808
  v_mov_b32 v9, s54
L_p_loop:
  s_mov_b32 s47, 0
L_p_w0:
  ds_read_b32 v3, v4 offset:16936
  s_waitcnt lgkmcnt(0)
  v_readfirstlane_b32 s42, v3
  s_add_u32 s47, s47, 1
  s_cmp_ge_u32 s42, s52
  s_cbranch_scc1 L_p_w0_ok
  s_sleep 8
  s_cmp_lt_u32 s47, 0x100000
  s_cbranch_scc1 L_p_w0
L_p_w0_ok:
  ds_read_b32 v8, v4 offset:16940
  s_lshl_b32 s41, s2, 3
  s_add_u32 s41, s41, s53
  s_add_u32 s52, s52, 2
  s_waitcnt lgkmcnt(0)
  v_readfirstlane_b32 s43, v8
  s_cmp_lt_u32 s2, 32
  s_cbranch_scc0 L_p_nopub
  s_mov_b64 exec, 1
  buffer_store_dwordx2 v[8:9], off, s[48:51], s41 sc1
  s_mov_b64 exec, -1
L_p_nopub:
  s_mov_b32 s47, 0
L_p_w1:
  ds_read_b32 v3, v4 offset:16936
  s_waitcnt lgkmcnt(0)
  v_readfirstlane_b32 s42, v3
  s_add_u32 s47, s47, 1
  s_cmp_ge_u32 s42, s52
  s_cbranch_scc1 L_p_w1_ok
  s_sleep 8
  s_cmp_lt_u32 s47, 0x100000
  s_cbranch_scc1 L_p_w1
L_p_w1_ok:
  s_mov_b32 s44, 0
L_p_sum:
  s_load_dwordx16 s[16:31], s[38:39], s53
  s_add_u32 s53, s53, 64
  s_waitcnt lgkmcnt(0)
  s_sub_u32 s41, s16, s43
  s_cmp_eq_u32 s17, s54
  s_cselect_b32 s41, s41, 436
  s_add_u32 s44, s44, s41
  s_sub_u32 s41, s18, s43
  s_cmp_eq_u32 s19, s54
  s_cselect_b32 s41, s41, 436
  s_add_u32 s44, s44, s41
  s_sub_u32 s41, s20, s43
  s_cmp_eq_u32 s21, s54
  s_cselect_b32 s41, s41, 436
  s_add_u32 s44, s44, s41
  s_sub_u32 s41, s22, s43
  s_cmp_eq_u32 s23, s54
  s_cselect_b32 s41, s41, 436
  s_add_u32 s44, s44, s41
  s_sub_u32 s41, s24, s43
  s_cmp_eq_u32 s25, s54
  s_cselect_b32 s41, s41, 436
  s_add_u32 s44, s44, s41
  s_sub_u32 s41, s26, s43
  s_cmp_eq_u32 s27, s54
  s_cselect_b32 s41, s41, 436
  s_add_u32 s44, s44, s41
  s_sub_u32 s41, s28, s43
  s_cmp_eq_u32 s29, s54
  s_cselect_b32 s41, s41, 436
  s_add_u32 s44, s44, s41
  s_sub_u32 s41, s30, s43
  s_cmp_eq_u32 s31, s54
  s_cselect_b32 s41, s41, 436
  s_add_u32 s44, s44, s41
  s_and_b32 s41, s53, 0xff
  s_cbranch_scc1 L_p_sum
  s_ashr_i32 s44, s44, 5
  s_add_u32 s44, s44, s43
  v_mov_b32 v7, s44
  ds_write_b32 v4, v7 offset:16944
  s_add_u32 s52, s52, 4
  s_cmp_lt_u32 s52, 33
  s_cbranch_scc1 L_p_loop
  s_branch L_h_nocons
.p2align 12
L_pad:
  s_branch L_pad_ret
L_post:
  s_waitcnt lgkmcnt(0)
  s_barrier
  ds_read_b128 v[44:47], v53 offset:16640
  s_waitcnt vmcnt(4)
  buffer_load_dwordx4 v[180:183], v48, s[8:11], s12 offen nt
  s_waitcnt lgkmcnt(0)
  s_mov_b32 s44, 0xf000f
  s_mov_b32 s45, 0xf000f
  v_cndmask_b32 v16, 0, v44, s[44:45]
  v_cndmask_b32 v17, 0, v45, s[44:45]
  v_cndmask_b32 v18, 0, v46, s[44:45]
  v_cndmask_b32 v19, 0, v47, s[44:45]
  s_waitcnt vmcnt(4)
  buffer_load_dwordx4 v[184:187], v49, s[8:11], s12 offen nt
  s_mov_b32 s44, 0xf000f0
  s_mov_b32 s45, 0xf000f0
  v_cndmask_b32 v20, 0, v44, s[44:45]
  v_cndmask_b32 v21, 0, v45, s[44:45]
  v_cndmask_b32 v22, 0, v46, s[44:45]
  v_cndmask_b32 v23, 0, v47, s[44:45]
  s_waitcnt vmcnt(4)
  buffer_load_dwordx4 v[188:191], v50, s[8:11], s12 offen nt
  s_mov_b32 s44, 0xf000f00
  s_mov_b32 s45, 0xf000f00
  v_cndmask_b32 v24, 0, v44, s[44:45]
  v_cndmask_b32 v25, 0, v45, s[44:45]
  v_cndmask_b32 v26, 0, v46, s[44:45]
  v_cndmask_b32 v27, 0, v47, s[44:45]
  s_mov_b32 s44, 0xf000f000
  s_mov_b32 s45, 0xf000f000
  v_cndmask_b32 v28, 0, v44, s[44:45]
  v_cndmask_b32 v29, 0, v45, s[44:45]
  v_cndmask_b32 v30, 0, v46, s[44:45]
  v_cndmask_b32 v31, 0, v47, s[44:45]
  s_nop 1
  s_mov_b64 vcc, 0
  v_mfma_f32_16x16x32_bf16 v[32:35], v[16:19], v[64:67], 0
  s_waitcnt vmcnt(4)
  s_and_b32 s59, s13, 7
  s_mul_i32 s59, s59, 0x4800
  s_and_b32 s59, s59, 0x7000
  s_and_b32 s12, s13, 1
  s_lshl_b32 s12, s12, 10
  s_or_b32 s59, s59, s12
  s_lshl_b32 s12, s13, 19
  s_or_b32 s59, s59, s12
  s_xor_b32 s59, s59, s14
  s_add_u32 s13, s13, 1
  s_and_b32 s13, s13, 15
  buffer_load_dwordx4 v[64:67], v3, s[8:11], s59 offen nt
  v_mfma_f32_16x16x32_bf16 v[32:35], v[20:23], v[68:71], v[32:35]
  s_waitcnt vmcnt(4)
  buffer_load_dwordx4 v[68:71], v48, s[8:11], s59 offen nt
  v_mfma_f32_16x16x32_bf16 v[32:35], v[24:27], v[72:75], v[32:35]
  s_waitcnt vmcnt(4)
  buffer_load_dwordx4 v[72:75], v49, s[8:11], s59 offen nt
  v_mfma_f32_16x16x32_bf16 v[32:35], v[28:31], v[76:79], v[32:35]
  s_waitcnt vmcnt(4)
  buffer_load_dwordx4 v[76:79], v50, s[8:11], s59 offen nt
  v_mfma_f32_16x16x32_bf16 v[36:39], v[16:19], v[80:83], 0
  s_waitcnt vmcnt(4)
  s_xor_b32 s12, s59, 0x20400
  buffer_load_dwordx4 v[80:83], v3, s[8:11], s12 offen nt
  v_mfma_f32_16x16x32_bf16 v[36:39], v[20:23], v[84:87], v[36:39]
  v_mfma_f32_16x16x32_bf16 v[36:39], v[24:27], v[88:91], v[36:39]
  s_nop 1
  v_cndmask_b32 v6, v32, v33, s[40:41]
  v_cndmask_b32 v7, v34, v35, s[40:41]
  v_cndmask_b32 v6, v6, v7, s[42:43]
  s_nop 1
  v_add_f32_dpp v6, v6, v6 quad_perm:[1,0,3,2] row_mask:0xf bank_mask:0xf
  s_nop 1
  v_add_f32_dpp v6, v6, v6 quad_perm:[2,3,0,1] row_mask:0xf bank_mask:0xf
  v_max_f32 v5, v5, v6
  ds_write_b32 v8, v6 offset:64
  v_mfma_f32_16x16x32_bf16 v[36:39], v[28:31], v[92:95], v[36:39]
  v_mfma_f32_16x16x32_bf16 v[32:35], v[16:19], v[96:99], 0
  v_mfma_f32_16x16x32_bf16 v[32:35], v[20:23], v[100:103], v[32:35]
  v_mfma_f32_16x16x32_bf16 v[32:35], v[24:27], v[104:107], v[32:35]
  s_nop 4
  v_cndmask_b32 v6, v36, v37, s[40:41]
  v_cndmask_b32 v7, v38, v39, s[40:41]
  v_cndmask_b32 v6, v6, v7, s[42:43]
  s_nop 1
  v_add_f32_dpp v6, v6, v6 quad_perm:[1,0,3,2] row_mask:0xf bank_mask:0xf
  s_nop 1
  v_add_f32_dpp v6, v6, v6 quad_perm:[2,3,0,1] row_mask:0xf bank_mask:0xf
  v_max_f32 v5, v5, v6
  ds_write_b32 v8, v6 offset:128
  v_mfma_f32_16x16x32_bf16 v[32:35], v[28:31], v[108:111], v[32:35]
  v_mfma_f32_16x16x32_bf16 v[36:39], v[16:19], v[112:115], 0
  v_mfma_f32_16x16x32_bf16 v[36:39], v[20:23], v[116:119], v[36:39]
  v_mfma_f32_16x16x32_bf16 v[36:39], v[24:27], v[120:123], v[36:39]
  s_nop 4
  v_cndmask_b32 v6, v32, v33, s[40:41]
  v_cndmask_b32 v7, v34, v35, s[40:41]
  v_cndmask_b32 v6, v6, v7, s[42:43]
  s_nop 1
  v_add_f32_dpp v6, v6, v6 quad_perm:[1,0,3,2] row_mask:0xf bank_mask:0xf
  s_nop 1
  v_add_f32_dpp v6, v6, v6 quad_perm:[2,3,0,1] row_mask:0xf bank_mask:0xf
  v_max_f32 v5, v5, v6
  ds_write_b32 v8, v6 offset:192
  v_mfma_f32_16x16x32_bf16 v[36:39], v[28:31], v[124:127], v[36:39]
  v_add_u32 v8, 256, v8
  s_waitcnt vmcnt(4)
  buffer_load_dwordx4 v[84:87], v48, s[8:11], s12 offen nt
  v_mfma_f32_16x16x32_bf16 v[32:35], v[16:19], v[128:131], 0
  v_mfma_f32_16x16x32_bf16 v[32:35], v[20:23], v[132:135], v[32:35]
  v_mfma_f32_16x16x32_bf16 v[32:35], v[24:27], v[136:139], v[32:35]
  s_nop 2
  v_cndmask_b32 v6, v36, v37, s[40:41]
  v_cndmask_b32 v7, v38, v39, s[40:41]
  v_cndmask_b32 v6, v6, v7, s[42:43]
  s_nop 1
  v_add_f32_dpp v6, v6, v6 quad_perm:[1,0,3,2] row_mask:0xf bank_mask:0xf
  s_nop 1
  v_add_f32_dpp v6, v6, v6 quad_perm:[2,3,0,1] row_mask:0xf bank_mask:0xf
  v_max_f32 v5, v5, v6
  ds_write_b32 v8, v6 offset:0
  v_mfma_f32_16x16x32_bf16 v[32:35], v[28:31], v[140:143], v[32:35]
  v_mfma_f32_16x16x32_bf16 v[36:39], v[16:19], v[144:147], 0
  v_mfma_f32_16x16x32_bf16 v[36:39], v[20:23], v[148:151], v[36:39]
  v_mfma_f32_16x16x32_bf16 v[36:39], v[24:27], v[152:155], v[36:39]
  s_nop 4
  v_cndmask_b32 v6, v32, v33, s[40:41]
  v_cndmask_b32 v7, v34, v35, s[40:41]
  v_cndmask_b32 v6, v6, v7, s[42:43]
  s_nop 1
  v_add_f32_dpp v6, v6, v6 quad_perm:[1,0,3,2] row_mask:0xf bank_mask:0xf
  s_nop 1
  v_add_f32_dpp v6, v6, v6 quad_perm:[2,3,0,1] row_mask:0xf bank_mask:0xf
  v_max_f32 v5, v5, v6
  ds_write_b32 v8, v6 offset:64
  v_mfma_f32_16x16x32_bf16 v[36:39], v[28:31], v[156:159], v[36:39]
  v_mfma_f32_16x16x32_bf16 v[32:35], v[16:19], v[160:163], 0
  v_mfma_f32_16x16x32_bf16 v[32:35], v[20:23], v[164:167], v[32:35]
  v_mfma_f32_16x16x32_bf16 v[32:35], v[24:27], v[168:171], v[32:35]
  s_nop 4
  v_cndmask_b32 v6, v36, v37, s[40:41]
  v_cndmask_b32 v7, v38, v39, s[40:41]
  v_cndmask_b32 v6, v6, v7, s[42:43]
  s_nop 1
  v_add_f32_dpp v6, v6, v6 quad_perm:[1,0,3,2] row_mask:0xf bank_mask:0xf
  s_nop 1
  v_add_f32_dpp v6, v6, v6 quad_perm:[2,3,0,1] row_mask:0xf bank_mask:0xf
  v_max_f32 v5, v5, v6
  ds_write_b32 v8, v6 offset:128
  v_mfma_f32_16x16x32_bf16 v[32:35], v[28:31], v[172:175], v[32:35]
  v_mfma_f32_16x16x32_bf16 v[36:39], v[16:19], v[176:179], 0
  v_mfma_f32_16x16x32_bf16 v[36:39], v[20:23], v[180:183], v[36:39]
  v_mfma_f32_16x16x32_bf16 v[36:39], v[24:27], v[184:187], v[36:39]
  s_nop 4
  v_cndmask_b32 v6, v32, v33, s[40:41]
  v_cndmask_b32 v7, v34, v35, s[40:41]
  v_cndmask_b32 v6, v6, v7, s[42:43]
  s_nop 1
  v_add_f32_dpp v6, v6, v6 quad_perm:[1,0,3,2] row_mask:0xf bank_mask:0xf
  s_nop 1
  v_add_f32_dpp v6, v6, v6 quad_perm:[2,3,0,1] row_mask:0xf bank_mask:0xf
  v_max_f32 v5, v5, v6
  ds_write_b32 v8, v6 offset:192
  s_waitcnt vmcnt(4)
  buffer_load_dwordx4 v[88:91], v49, s[8:11], s12 offen nt
  v_mfma_f32_16x16x32_bf16 v[36:39], v[28:31], v[188:191], v[36:39]
  v_add_u32 v8, 256, v8
  s_mov_b32 s15, 2
  s_memrealtime s[64:65]
  ds_read_b32 v59, v56 offset:16944
L_kloop:
  s_waitcnt lgkmcnt(0)
  v_readfirstlane_b32 s66, v59
  s_add_u32 s67, s15, 0
  s_mul_i32 s68, s67, 218
  s_sub_u32 s68, s64, s68
  v_mov_b32 v58, s67
  v_mov_b32 v59, s68
  ds_write_b64 v57, v[58:59] offset:16936
  s_sub_u32 s68, s68, s66
  s_add_u32 s69, s68, 2000
  s_cmp_lt_u32 s69, 1950
  s_cselect_b32 s69, 1, 0
  s_cmp_gt_i32 s68, 20
  s_cselect_b64 vcc, -1, 0
  s_cmp_eq_u32 s69, 0
  s_waitcnt vmcnt(6)
  s_cbranch_vccnz L_dw1
  s_waitcnt vmcnt(4)
  s_cbranch_scc1 L_dw1
  s_waitcnt vmcnt(3)
L_dw1:
  buffer_load_dwordx4 v[92:95], v50, s[8:11], s12 offen nt
  v_mfma_f32_16x16x32_bf16 v[32:35], v[16:19], v[64:67], 0
  s_waitcnt vmcnt(6)
  s_cbranch_vccnz L_dw2
  s_waitcnt vmcnt(4)
  s_cbranch_scc1 L_dw2
  s_waitcnt vmcnt(3)
L_dw2:
  s_xor_b32 s12, s59, 0x40800
  buffer_load_dwordx4 v[96:99], v3, s[8:11], s12 offen nt
  s_cmp_eq_u32 s69, 0
  v_mfma_f32_16x16x32_bf16 v[32:35], v[20:23], v[68:71], v[32:35]
  s_waitcnt vmcnt(6)
  s_cbranch_vccnz L_dw3
  s_waitcnt vmcnt(4)
  s_cbranch_scc1 L_dw3
  s_waitcnt vmcnt(3)
L_dw3:
  buffer_load_dwordx4 v[100:103], v48, s[8:11], s12 offen nt
  v_mfma_f32_16x16x32_bf16 v[32:35], v[24:27], v[72:75], v[32:35]
  v_cndmask_b32 v6, v36, v37, s[40:41]
  v_cndmask_b32 v7, v38, v39, s[40:41]
  v_cndmask_b32 v6, v6, v7, s[42:43]
  s_nop 1
  v_add_f32_dpp v6, v6, v6 quad_perm:[1,0,3,2] row_mask:0xf bank_mask:0xf
  s_nop 1
  v_add_f32_dpp v6, v6, v6 quad_perm:[2,3,0,1] row_mask:0xf bank_mask:0xf
  v_max_f32 v5, v5, v6
  ds_write_b32 v8, v6 offset:0
  s_waitcnt vmcnt(6)
  s_cbranch_vccnz L_dw4
  s_waitcnt vmcnt(4)
  s_cbranch_scc1 L_dw4
  s_waitcnt vmcnt(3)
L_dw4:
  buffer_load_dwordx4 v[104:107], v49, s[8:11], s12 offen nt
  v_mfma_f32_16x16x32_bf16 v[32:35], v[28:31], v[76:79], v[32:35]
  s_waitcnt vmcnt(6)
  s_cbranch_vccnz L_dw5
  s_waitcnt vmcnt(4)
  s_cbranch_scc1 L_dw5
  s_waitcnt vmcnt(3)
L_dw5:
  buffer_load_dwordx4 v[108:111], v50, s[8:11], s12 offen nt
  v_mfma_f32_16x16x32_bf16 v[36:39], v[16:19], v[80:83], 0
  s_waitcnt vmcnt(6)
  s_cbranch_vccnz L_dw6
  s_waitcnt vmcnt(4)
  s_cbranch_scc1 L_dw6
  s_waitcnt vmcnt(3)
L_dw6:
  s_xor_b32 s12, s59, 0x60c00
  buffer_load_dwordx4 v[112:115], v3, s[8:11], s12 offen nt
  s_cmp_eq_u32 s69, 0
  v_mfma_f32_16x16x32_bf16 v[36:39], v[20:23], v[84:87], v[36:39]
  s_waitcnt vmcnt(6)
  s_cbranch_vccnz L_dw7
  s_waitcnt vmcnt(4)
  s_cbranch_scc1 L_dw7
  s_waitcnt vmcnt(3)
L_dw7:
  buffer_load_dwordx4 v[116:119], v48, s[8:11], s12 offen nt
  v_mfma_f32_16x16x32_bf16 v[36:39], v[24:27], v[88:91], v[36:39]
  v_cndmask_b32 v6, v32, v33, s[40:41]
  v_cndmask_b32 v7, v34, v35, s[40:41]
  v_cndmask_b32 v6, v6, v7, s[42:43]
  s_nop 1
  v_add_f32_dpp v6, v6, v6 quad_perm:[1,0,3,2] row_mask:0xf bank_mask:0xf
  s_nop 1
  v_add_f32_dpp v6, v6, v6 quad_perm:[2,3,0,1] row_mask:0xf bank_mask:0xf
  v_max_f32 v5, v5, v6
  ds_write_b32 v8, v6 offset:64
  s_waitcnt vmcnt(6)
  s_cbranch_vccnz L_dw8
  s_waitcnt vmcnt(4)
  s_cbranch_scc1 L_dw8
  s_waitcnt vmcnt(3)
L_dw8:
  buffer_load_dwordx4 v[120:123], v49, s[8:11], s12 offen nt
  v_mfma_f32_16x16x32_bf16 v[36:39], v[28:31], v[92:95], v[36:39]
  s_waitcnt vmcnt(6)
  s_cbranch_vccnz L_dw9
  s_waitcnt vmcnt(4)
  s_cbranch_scc1 L_dw9
  s_waitcnt vmcnt(3)
L_dw9:
  buffer_load_dwordx4 v[124:127], v50, s[8:11], s12 offen nt
  v_mfma_f32_16x16x32_bf16 v[32:35], v[16:19], v[96:99], 0
  s_waitcnt vmcnt(6)
  s_cbranch_vccnz L_dw10
  s_waitcnt vmcnt(4)
  s_cbranch_scc1 L_dw10
  s_waitcnt vmcnt(3)
L_dw10:
  s_cmp_eq_u32 s15, 15
  s_cselect_b32 s8, s20, s8
  s_cselect_b32 s9, s21, s9
  s_cselect_b64 s[44:45], -1, 0
  v_cndmask_b32 v3, v3, v4, s[44:45]
  v_add_u32 v48, 0x10000, v3
  v_add_u32 v49, 0x8000, v3
  v_add_u32 v50, 0x18000, v3
  s_and_b32 s59, s13, 7
  s_mul_i32 s59, s59, 0x4800
  s_and_b32 s59, s59, 0x7000
  s_and_b32 s12, s13, 1
  s_lshl_b32 s12, s12, 10
  s_or_b32 s59, s59, s12
  s_lshl_b32 s12, s13, 19
  s_or_b32 s59, s59, s12
  s_xor_b32 s59, s59, s14
  s_add_u32 s13, s13, 1
  s_and_b32 s13, s13, 15
  buffer_load_dwordx4 v[64:67], v3, s[8:11], s59 offen nt
  s_cmp_eq_u32 s69, 0
  v_mfma_f32_16x16x32_bf16 v[32:35], v[20:23], v[100:103], v[32:35]
  s_waitcnt vmcnt(6)
  s_cbranch_vccnz L_dw11
  s_waitcnt vmcnt(4)
  s_cbranch_scc1 L_dw11
  s_waitcnt vmcnt(3)
L_dw11:
  buffer_load_dwordx4 v[68:71], v48, s[8:11], s59 offen nt
  v_mfma_f32_16x16x32_bf16 v[32:35], v[24:27], v[104:107], v[32:35]
  v_cndmask_b32 v6, v36, v37, s[40:41]
  v_cndmask_b32 v7, v38, v39, s[40:41]
  v_cndmask_b32 v6, v6, v7, s[42:43]
  s_nop 1
  v_add_f32_dpp v6, v6, v6 quad_perm:[1,0,3,2] row_mask:0xf bank_mask:0xf
  s_nop 1
  v_add_f32_dpp v6, v6, v6 quad_perm:[2,3,0,1] row_mask:0xf bank_mask:0xf
  v_max_f32 v5, v5, v6
  ds_write_b32 v8, v6 offset:128
  s_waitcnt vmcnt(6)
  s_cbranch_vccnz L_dw12
  s_waitcnt vmcnt(4)
  s_cbranch_scc1 L_dw12
  s_waitcnt vmcnt(3)
L_dw12:
  buffer_load_dwordx4 v[72:75], v49, s[8:11], s59 offen nt
  v_mfma_f32_16x16x32_bf16 v[32:35], v[28:31], v[108:111], v[32:35]
  s_waitcnt vmcnt(6)
  s_cbranch_vccnz L_dw13
  s_waitcnt vmcnt(4)
  s_cbranch_scc1 L_dw13
  s_waitcnt vmcnt(3)
L_dw13:
  buffer_load_dwordx4 v[76:79], v50, s[8:11], s59 offen nt
  v_mfma_f32_16x16x32_bf16 v[36:39], v[16:19], v[112:115], 0
  s_waitcnt vmcnt(6)
  s_cbranch_vccnz L_dw14
  s_waitcnt vmcnt(4)
  s_cbranch_scc1 L_dw14
  s_waitcnt vmcnt(3)
L_dw14:
  s_xor_b32 s12, s59, 0x20400
  buffer_load_dwordx4 v[80:83], v3, s[8:11], s12 offen nt
  s_cmp_eq_u32 s69, 0
  v_mfma_f32_16x16x32_bf16 v[36:39], v[20:23], v[116:119], v[36:39]
  s_waitcnt vmcnt(6)
  s_cbranch_vccnz L_dw15
  s_waitcnt vmcnt(4)
  s_cbranch_scc1 L_dw15
  s_waitcnt vmcnt(3)
L_dw15:
  buffer_load_dwordx4 v[84:87], v48, s[8:11], s12 offen nt
  v_mfma_f32_16x16x32_bf16 v[36:39], v[24:27], v[120:123], v[36:39]
  v_cndmask_b32 v6, v32, v33, s[40:41]
  v_cndmask_b32 v7, v34, v35, s[40:41]
  v_cndmask_b32 v6, v6, v7, s[42:43]
  s_nop 1
  v_add_f32_dpp v6, v6, v6 quad_perm:[1,0,3,2] row_mask:0xf bank_mask:0xf
  s_nop 1
  v_add_f32_dpp v6, v6, v6 quad_perm:[2,3,0,1] row_mask:0xf bank_mask:0xf
  v_max_f32 v5, v5, v6
  ds_write_b32 v8, v6 offset:192
  s_memrealtime s[64:65]
  ds_read_b32 v59, v56 offset:16944
  s_waitcnt vmcnt(6)
  s_cbranch_vccnz L_dw16
  s_waitcnt vmcnt(4)
  s_cbranch_scc1 L_dw16
  s_waitcnt vmcnt(3)
L_dw16:
  buffer_load_dwordx4 v[88:91], v49, s[8:11], s12 offen nt
  v_mfma_f32_16x16x32_bf16 v[36:39], v[28:31], v[124:127], v[36:39]
  v_add_u32 v8, 256, v8
  s_add_u32 s15, s15, 1
  s_cmp_lt_u32 s15, 16
  s_cbranch_scc1 L_kloop
  s_nop 5
  v_cndmask_b32 v6, v36, v37, s[40:41]
  v_cndmask_b32 v7, v38, v39, s[40:41]
  v_cndmask_b32 v6, v6, v7, s[42:43]
  s_nop 1
  v_add_f32_dpp v6, v6, v6 quad_perm:[1,0,3,2] row_mask:0xf bank_mask:0xf
  s_nop 1
  v_add_f32_dpp v6, v6, v6 quad_perm:[2,3,0,1] row_mask:0xf bank_mask:0xf
  v_max_f32 v5, v5, v6
  ds_write_b32 v8, v6 offset:0
  s_lshl_b32 s7, s3, 12
  v_lshl_add_u32 v8, v2, 2, v1
  v_lshlrev_b32 v8, 2, v8
  v_add_u32 v8, s7, v8
  ds_read_b32 v11, v8 offset:64
  s_nop 1
  v_max_f32_dpp v5, v5, v5 row_ror:4 row_mask:0xf bank_mask:0xf
  s_nop 1
  v_max_f32_dpp v5, v5, v5 row_ror:8 row_mask:0xf bank_mask:0xf
  v_mov_b32 v6, v5
  s_nop 1
  v_permlane16_swap_b32 v5, v6
  s_nop 0
  v_max_f32 v5, v5, v6
  v_mov_b32 v6, v5
  s_nop 1
  v_permlane32_swap_b32 v5, v6
  s_nop 0
  v_max_f32 v5, v5, v6
  v_cvt_pk_bf16_f32 v9, v5, v5
  v_and_b32 v9, 0xffff0000, v9
  v_mul_f32 v9, 0x3db504f3, v9
  v_cvt_pk_bf16_f32 v9, v9, v9
  v_and_b32 v9, 0xffff0000, v9
  ds_write_b32 v61, v9 offset:16896
  v_mov_b32 v5, 0
  v_mov_b32 v63, 0
  v_mov_b32 v40, 0
  v_mov_b32 v41, 0
  v_mov_b32 v42, 0
  v_mov_b32 v43, 0
  s_mov_b32 s15, 0
L_vloop:
  s_waitcnt lgkmcnt(0)
  v_readfirstlane_b32 s66, v59
  s_add_u32 s67, s15, 16
  s_mul_i32 s68, s67, 218
  s_sub_u32 s68, s64, s68
  v_mov_b32 v58, s67
  v_mov_b32 v59, s68
  ds_write_b64 v57, v[58:59] offset:16936
  s_sub_u32 s68, s68, s66
  s_add_u32 s69, s68, 2000
  s_cmp_lt_u32 s69, 1950
  s_cselect_b32 s69, 1, 0
  s_cmp_gt_i32 s68, 20
  s_cselect_b64 vcc, -1, 0
  s_cmp_eq_u32 s69, 0
  s_waitcnt lgkmcnt(0)
  v_cvt_pk_bf16_f32 v10, v11, v11
  v_and_b32 v10, 0xffff0000, v10
  v_mul_f32 v10, 0x3db504f3, v10
  v_cvt_pk_bf16_f32 v10, v10, v10
  v_and_b32 v10, 0xffff0000, v10
  v_sub_f32 v10, v10, v9
  v_mul_f32 v10, 0x3fb8aa3b, v10
  v_exp_f32 v10, v10
  ds_read_b32 v11, v8 offset:320
  v_add_u32 v8, 256, v8
  v_add_f32 v5, v5, v10
  v_cvt_pk_bf16_f32 v10, v10, v10
  s_nop 1
  v_and_b32_dpp v16, v10, v12 row_newbcast:0 row_mask:0xf bank_mask:0xf
  v_and_b32_dpp v17, v10, v13 row_newbcast:0 row_mask:0xf bank_mask:0xf
  v_and_b32_dpp v18, v10, v14 row_newbcast:0 row_mask:0xf bank_mask:0xf
  v_and_b32_dpp v19, v10, v15 row_newbcast:0 row_mask:0xf bank_mask:0xf
  s_waitcnt vmcnt(6)
  s_cbranch_vccnz L_dw17
  s_waitcnt vmcnt(4)
  s_cbranch_scc1 L_dw17
  s_waitcnt vmcnt(3)
L_dw17:
  buffer_load_dwordx4 v[92:95], v50, s[8:11], s12 offen nt
  v_mfma_f32_16x16x32_bf16 v[40:43], v[16:19], v[64:67], v[40:43]
  v_and_b32_dpp v16, v10, v12 row_newbcast:1 row_mask:0xf bank_mask:0xf
  v_and_b32_dpp v17, v10, v13 row_newbcast:1 row_mask:0xf bank_mask:0xf
  v_and_b32_dpp v18, v10, v14 row_newbcast:1 row_mask:0xf bank_mask:0xf
  v_and_b32_dpp v19, v10, v15 row_newbcast:1 row_mask:0xf bank_mask:0xf
  s_waitcnt vmcnt(6)
  s_cbranch_vccnz L_dw18
  s_waitcnt vmcnt(4)
  s_cbranch_scc1 L_dw18
  s_waitcnt vmcnt(3)
L_dw18:
  s_xor_b32 s12, s59, 0x40800
  buffer_load_dwordx4 v[96:99], v3, s[8:11], s12 offen nt
  s_cmp_eq_u32 s69, 0
  v_mfma_f32_16x16x32_bf16 v[40:43], v[16:19], v[68:71], v[40:43]
  v_and_b32_dpp v16, v10, v12 row_newbcast:2 row_mask:0xf bank_mask:0xf
  v_and_b32_dpp v17, v10, v13 row_newbcast:2 row_mask:0xf bank_mask:0xf
  v_and_b32_dpp v18, v10, v14 row_newbcast:2 row_mask:0xf bank_mask:0xf
  v_and_b32_dpp v19, v10, v15 row_newbcast:2 row_mask:0xf bank_mask:0xf
  s_waitcnt vmcnt(6)
  s_cbranch_vccnz L_dw19
  s_waitcnt vmcnt(4)
  s_cbranch_scc1 L_dw19
  s_waitcnt vmcnt(3)
L_dw19:
  buffer_load_dwordx4 v[100:103], v48, s[8:11], s12 offen nt
  v_mfma_f32_16x16x32_bf16 v[40:43], v[16:19], v[72:75], v[40:43]
  v_and_b32_dpp v16, v10, v12 row_newbcast:3 row_mask:0xf bank_mask:0xf
  v_and_b32_dpp v17, v10, v13 row_newbcast:3 row_mask:0xf bank_mask:0xf
  v_and_b32_dpp v18, v10, v14 row_newbcast:3 row_mask:0xf bank_mask:0xf
  v_and_b32_dpp v19, v10, v15 row_newbcast:3 row_mask:0xf bank_mask:0xf
  s_waitcnt vmcnt(6)
  s_cbranch_vccnz L_dw20
  s_waitcnt vmcnt(4)
  s_cbranch_scc1 L_dw20
  s_waitcnt vmcnt(3)
L_dw20:
  buffer_load_dwordx4 v[104:107], v49, s[8:11], s12 offen nt
  v_mfma_f32_16x16x32_bf16 v[40:43], v[16:19], v[76:79], v[40:43]
  v_and_b32_dpp v16, v10, v12 row_newbcast:4 row_mask:0xf bank_mask:0xf
  v_and_b32_dpp v17, v10, v13 row_newbcast:4 row_mask:0xf bank_mask:0xf
  v_and_b32_dpp v18, v10, v14 row_newbcast:4 row_mask:0xf bank_mask:0xf
  v_and_b32_dpp v19, v10, v15 row_newbcast:4 row_mask:0xf bank_mask:0xf
  s_waitcnt vmcnt(6)
  s_cbranch_vccnz L_dw21
  s_waitcnt vmcnt(4)
  s_cbranch_scc1 L_dw21
  s_waitcnt vmcnt(3)
L_dw21:
  buffer_load_dwordx4 v[108:111], v50, s[8:11], s12 offen nt
  v_mfma_f32_16x16x32_bf16 v[40:43], v[16:19], v[80:83], v[40:43]
  v_and_b32_dpp v16, v10, v12 row_newbcast:5 row_mask:0xf bank_mask:0xf
  v_and_b32_dpp v17, v10, v13 row_newbcast:5 row_mask:0xf bank_mask:0xf
  v_and_b32_dpp v18, v10, v14 row_newbcast:5 row_mask:0xf bank_mask:0xf
  v_and_b32_dpp v19, v10, v15 row_newbcast:5 row_mask:0xf bank_mask:0xf
  s_waitcnt vmcnt(6)
  s_cbranch_vccnz L_dw22
  s_waitcnt vmcnt(4)
  s_cbranch_scc1 L_dw22
  s_waitcnt vmcnt(3)
L_dw22:
  s_xor_b32 s12, s59, 0x60c00
  buffer_load_dwordx4 v[112:115], v3, s[8:11], s12 offen nt
  s_cmp_eq_u32 s69, 0
  v_mfma_f32_16x16x32_bf16 v[40:43], v[16:19], v[84:87], v[40:43]
  v_and_b32_dpp v16, v10, v12 row_newbcast:6 row_mask:0xf bank_mask:0xf
  v_and_b32_dpp v17, v10, v13 row_newbcast:6 row_mask:0xf bank_mask:0xf
  v_and_b32_dpp v18, v10, v14 row_newbcast:6 row_mask:0xf bank_mask:0xf
  v_and_b32_dpp v19, v10, v15 row_newbcast:6 row_mask:0xf bank_mask:0xf
  s_waitcnt vmcnt(6)
  s_cbranch_vccnz L_dw23
  s_waitcnt vmcnt(4)
  s_cbranch_scc1 L_dw23
  s_waitcnt vmcnt(3)
L_dw23:
  buffer_load_dwordx4 v[116:119], v48, s[8:11], s12 offen nt
  v_mfma_f32_16x16x32_bf16 v[40:43], v[16:19], v[88:91], v[40:43]
  v_and_b32_dpp v16, v10, v12 row_newbcast:7 row_mask:0xf bank_mask:0xf
  v_and_b32_dpp v17, v10, v13 row_newbcast:7 row_mask:0xf bank_mask:0xf
  v_and_b32_dpp v18, v10, v14 row_newbcast:7 row_mask:0xf bank_mask:0xf
  v_and_b32_dpp v19, v10, v15 row_newbcast:7 row_mask:0xf bank_mask:0xf
  s_waitcnt vmcnt(6)
  s_cbranch_vccnz L_dw24
  s_waitcnt vmcnt(4)
  s_cbranch_scc1 L_dw24
  s_waitcnt vmcnt(3)
L_dw24:
  buffer_load_dwordx4 v[120:123], v49, s[8:11], s12 offen nt
  v_mfma_f32_16x16x32_bf16 v[40:43], v[16:19], v[92:95], v[40:43]
  v_and_b32_dpp v16, v10, v12 row_newbcast:8 row_mask:0xf bank_mask:0xf
  v_and_b32_dpp v17, v10, v13 row_newbcast:8 row_mask:0xf bank_mask:0xf
  v_and_b32_dpp v18, v10, v14 row_newbcast:8 row_mask:0xf bank_mask:0xf
  v_and_b32_dpp v19, v10, v15 row_newbcast:8 row_mask:0xf bank_mask:0xf
  s_waitcnt vmcnt(6)
  s_cbranch_vccnz L_dw25
  s_waitcnt vmcnt(4)
  s_cbranch_scc1 L_dw25
  s_waitcnt vmcnt(3)
L_dw25:
  buffer_load_dwordx4 v[124:127], v50, s[8:11], s12 offen nt
  v_mfma_f32_16x16x32_bf16 v[40:43], v[16:19], v[96:99], v[40:43]
  v_add_u32 v63, 1, v63
  ds_write_b32 v62, v5 offset:16960
  ds_write_b32 v61, v63 offset:16912
  v_and_b32_dpp v16, v10, v12 row_newbcast:9 row_mask:0xf bank_mask:0xf
  v_and_b32_dpp v17, v10, v13 row_newbcast:9 row_mask:0xf bank_mask:0xf
  v_and_b32_dpp v18, v10, v14 row_newbcast:9 row_mask:0xf bank_mask:0xf
  v_and_b32_dpp v19, v10, v15 row_newbcast:9 row_mask:0xf bank_mask:0xf
  s_waitcnt vmcnt(6)
  s_cbranch_vccnz L_dw26
  s_waitcnt vmcnt(4)
  s_cbranch_scc1 L_dw26
  s_waitcnt vmcnt(3)
L_dw26:
  s_cmp_eq_u32 s15, 15
  s_cselect_b32 s10, 0, s10
  s_and_b32 s59, s13, 7
  s_mul_i32 s59, s59, 0x4800
  s_and_b32 s59, s59, 0x7000
  s_and_b32 s12, s13, 1
  s_lshl_b32 s12, s12, 10
  s_or_b32 s59, s59, s12
  s_lshl_b32 s12, s13, 19
  s_or_b32 s59, s59, s12
  s_xor_b32 s59, s59, s14
  s_add_u32 s13, s13, 1
  s_and_b32 s13, s13, 15
  buffer_load_dwordx4 v[64:67], v3, s[8:11], s59 offen nt
  s_cmp_eq_u32 s69, 0
  v_mfma_f32_16x16x32_bf16 v[40:43], v[16:19], v[100:103], v[40:43]
  v_and_b32_dpp v16, v10, v12 row_newbcast:10 row_mask:0xf bank_mask:0xf
  v_and_b32_dpp v17, v10, v13 row_newbcast:10 row_mask:0xf bank_mask:0xf
  v_and_b32_dpp v18, v10, v14 row_newbcast:10 row_mask:0xf bank_mask:0xf
  v_and_b32_dpp v19, v10, v15 row_newbcast:10 row_mask:0xf bank_mask:0xf
  s_waitcnt vmcnt(6)
  s_cbranch_vccnz L_dw27
  s_waitcnt vmcnt(4)
  s_cbranch_scc1 L_dw27
  s_waitcnt vmcnt(3)
L_dw27:
  buffer_load_dwordx4 v[68:71], v48, s[8:11], s59 offen nt
  v_mfma_f32_16x16x32_bf16 v[40:43], v[16:19], v[104:107], v[40:43]
  v_and_b32_dpp v16, v10, v12 row_newbcast:11 row_mask:0xf bank_mask:0xf
  v_and_b32_dpp v17, v10, v13 row_newbcast:11 row_mask:0xf bank_mask:0xf
  v_and_b32_dpp v18, v10, v14 row_newbcast:11 row_mask:0xf bank_mask:0xf
  v_and_b32_dpp v19, v10, v15 row_newbcast:11 row_mask:0xf bank_mask:0xf
  s_waitcnt vmcnt(6)
  s_cbranch_vccnz L_dw28
  s_waitcnt vmcnt(4)
  s_cbranch_scc1 L_dw28
  s_waitcnt vmcnt(3)
L_dw28:
  buffer_load_dwordx4 v[72:75], v49, s[8:11], s59 offen nt
  v_mfma_f32_16x16x32_bf16 v[40:43], v[16:19], v[108:111], v[40:43]
  v_and_b32_dpp v16, v10, v12 row_newbcast:12 row_mask:0xf bank_mask:0xf
  v_and_b32_dpp v17, v10, v13 row_newbcast:12 row_mask:0xf bank_mask:0xf
  v_and_b32_dpp v18, v10, v14 row_newbcast:12 row_mask:0xf bank_mask:0xf
  v_and_b32_dpp v19, v10, v15 row_newbcast:12 row_mask:0xf bank_mask:0xf
  s_waitcnt vmcnt(6)
  s_cbranch_vccnz L_dw29
  s_waitcnt vmcnt(4)
  s_cbranch_scc1 L_dw29
  s_waitcnt vmcnt(3)
L_dw29:
  buffer_load_dwordx4 v[76:79], v50, s[8:11], s59 offen nt
  v_mfma_f32_16x16x32_bf16 v[40:43], v[16:19], v[112:115], v[40:43]
  v_and_b32_dpp v16, v10, v12 row_newbcast:13 row_mask:0xf bank_mask:0xf
  v_and_b32_dpp v17, v10, v13 row_newbcast:13 row_mask:0xf bank_mask:0xf
  v_and_b32_dpp v18, v10, v14 row_newbcast:13 row_mask:0xf bank_mask:0xf
  v_and_b32_dpp v19, v10, v15 row_newbcast:13 row_mask:0xf bank_mask:0xf
  s_waitcnt vmcnt(6)
  s_cbranch_vccnz L_dw30
  s_waitcnt vmcnt(4)
  s_cbranch_scc1 L_dw30
  s_waitcnt vmcnt(3)
L_dw30:
  s_xor_b32 s12, s59, 0x20400
  buffer_load_dwordx4 v[80:83], v3, s[8:11], s12 offen nt
  s_cmp_eq_u32 s69, 0
  v_mfma_f32_16x16x32_bf16 v[40:43], v[16:19], v[116:119], v[40:43]
  v_and_b32_dpp v16, v10, v12 row_newbcast:14 row_mask:0xf bank_mask:0xf
  v_and_b32_dpp v17, v10, v13 row_newbcast:14 row_mask:0xf bank_mask:0xf
  v_and_b32_dpp v18, v10, v14 row_newbcast:14 row_mask:0xf bank_mask:0xf
  v_and_b32_dpp v19, v10, v15 row_newbcast:14 row_mask:0xf bank_mask:0xf
  s_waitcnt vmcnt(6)
  s_cbranch_vccnz L_dw31
  s_waitcnt vmcnt(4)
  s_cbranch_scc1 L_dw31
  s_waitcnt vmcnt(3)
L_dw31:
  buffer_load_dwordx4 v[84:87], v48, s[8:11], s12 offen nt
  v_mfma_f32_16x16x32_bf16 v[40:43], v[16:19], v[120:123], v[40:43]
  s_memrealtime s[64:65]
  ds_read_b32 v59, v56 offset:16944
  v_and_b32_dpp v16, v10, v12 row_newbcast:15 row_mask:0xf bank_mask:0xf
  v_and_b32_dpp v17, v10, v13 row_newbcast:15 row_mask:0xf bank_mask:0xf
  v_and_b32_dpp v18, v10, v14 row_newbcast:15 row_mask:0xf bank_mask:0xf
  v_and_b32_dpp v19, v10, v15 row_newbcast:15 row_mask:0xf bank_mask:0xf
  s_waitcnt vmcnt(6)
  s_cbranch_vccnz L_dw32
  s_waitcnt vmcnt(4)
  s_cbranch_scc1 L_dw32
  s_waitcnt vmcnt(3)
L_dw32:
  buffer_load_dwordx4 v[88:91], v49, s[8:11], s12 offen nt
  v_mfma_f32_16x16x32_bf16 v[40:43], v[16:19], v[124:127], v[40:43]
  s_add_u32 s15, s15, 1
  s_cmp_lt_u32 s15, 16
  s_cbranch_scc1 L_vloop
  s_mov_b32 exec_lo, -1
  s_mov_b32 exec_hi, 0
  s_nop 2
  ds_write_b128 v60, v[40:43] offset:17984
  s_waitcnt lgkmcnt(0)
  s_barrier
  s_endpgm
.section .rodata,"a"
.p2align 6
.amdhsa_kernel recurrent_scan__mha_block_cached__glu_gated_reglu__decode_kernel
  .amdhsa_next_free_vgpr 256
  .amdhsa_next_free_sgpr 102
  .amdhsa_accum_offset 256
  .amdhsa_group_segment_fixed_size 0
  .amdhsa_kernarg_size 96
  .amdhsa_user_sgpr_count 2
  .amdhsa_user_sgpr_kernarg_segment_ptr 1
  .amdhsa_system_sgpr_workgroup_id_x 1
  .amdhsa_float_denorm_mode_32 3
.end_amdhsa_kernel
```
